```python
import torch

def _softmax(x, axis=-1):
    return torch.softmax(x, dim=axis)
def _gelu(x):
    return torch.nn.functional.gelu(x, approximate="tanh")
def _silu(x):
    return torch.nn.functional.silu(x)
def _sigmoid(x):
    return torch.sigmoid(x)
def _layernorm(x, axis=-1, eps=1e-5):
    m = x.mean(dim=axis, keepdim=True)
    v = x.var(dim=axis, keepdim=True, unbiased=False)
    return (x - m) / torch.sqrt(v + eps)
def _scatter_add(tgt, idx, src, axis=0):
    return tgt.clone().index_add_(axis, idx, src)
def _segment_sum(src, seg, n):
    out = torch.zeros((n,) + src.shape[1:], dtype=src.dtype)
    return out.index_add_(0, seg, src)
def _pad(x, pw):
    flat = tuple(v for pair in reversed(pw) for v in pair)
    return torch.nn.functional.pad(x, flat)

kernel_name = 'interleave_layers__sliding_block_cached__sliding_block_cached__decode'

def setup_inputs():

    _w = (lambda a: (lambda t: t.to(torch.bfloat16) if t.is_floating_point() else t)(torch.as_tensor(a)))
    def _A_setup():
        B, Sq, D = 2, 1, 512
        Hq, Hkv, Sk, Dh = 32, 32, 8192, 128
        assert Hq % Hkv == 0, (Hq, Hkv)
        return {
            "x": _w((lambda *s: torch.randn(*s, dtype=torch.bfloat16) * 0.1)(B, Sq, D)),
            "k_cache": _w((lambda *s: torch.randn(*s, dtype=torch.bfloat16) * 0.8)(B, Hkv, Sk, Dh)),
            "v_cache": _w((lambda *s: torch.randn(*s, dtype=torch.bfloat16) * 3.2)(B, Hkv, Sk, Dh)),
            "wq": _w((lambda *s: torch.randn(*s, dtype=torch.bfloat16) * 0.8)(D, Hq * Dh) * (D ** -0.5)),
            "wo": _w((lambda *s: torch.randn(*s, dtype=torch.bfloat16) * 3.2)(Hq * Dh, D) * ((Hq * Dh) ** -0.5)),
        }
    _A_in = _A_setup()

    def _B_setup():
        B, Sq, D = 2, 1, 512
        Hq, Hkv, Sk, Dh = 32, 32, 8192, 128
        assert Hq % Hkv == 0, (Hq, Hkv)
        return {
            "x": _w((lambda *s: torch.randn(*s, dtype=torch.bfloat16) * 0.1)(B, Sq, D)),
            "k_cache": _w((lambda *s: torch.randn(*s, dtype=torch.bfloat16) * 1.6)(B, Hkv, Sk, Dh)),
            "v_cache": _w((lambda *s: torch.randn(*s, dtype=torch.bfloat16) * 1.6)(B, Hkv, Sk, Dh)),
            "wq": _w((lambda *s: torch.randn(*s, dtype=torch.bfloat16) * 1.6)(D, Hq * Dh) * (D ** -0.5)),
            "wo": _w((lambda *s: torch.randn(*s, dtype=torch.bfloat16) * 1.6)(Hq * Dh, D) * ((Hq * Dh) ** -0.5)),
        }
    _B_in = _B_setup()

    return {
        "A_x": _A_in["x"],
        "A_k_cache": _A_in["k_cache"],
        "A_v_cache": _A_in["v_cache"],
        "A_wq": _A_in["wq"],
        "A_wo": _A_in["wo"],
        "B_x": _B_in["x"],
        "B_k_cache": _B_in["k_cache"],
        "B_v_cache": _B_in["v_cache"],
        "B_wq": _B_in["wq"],
        "B_wo": _B_in["wo"],
    }

def reference(A_x, A_k_cache, A_v_cache, A_wq, A_wo, B_x, B_k_cache, B_v_cache, B_wq, B_wo):
    def _A_ref(x, k_cache, v_cache, wq, wo):
        B, Sq, D = x.shape
        Hq, Dh = 32, 128
        Hkv, Sk = k_cache.shape[1], k_cache.shape[2]
        W = min(4096, max(256, Sk // 4))
        rep = Hq // Hkv
        q = (lambda x, *d: x.permute(*d))((x @ wq).reshape(B, Sq, Hq, Dh), 0, 2, 1, 3)
        k = (lambda x, n, axis: torch.repeat_interleave(x, n, dim=axis))(k_cache[:, :, Sk - W:, :], rep, axis=1)
        v = (lambda x, n, axis: torch.repeat_interleave(x, n, dim=axis))(v_cache[:, :, Sk - W:, :], rep, axis=1)
        scores = torch.einsum("bhqd,bhkd->bhqk", q, k) * (Dh ** -0.5)
        p = _softmax(scores, axis=-1)
        o = torch.einsum("bhqk,bhkd->bhqd", p, v)
        return (lambda x, *d: x.permute(*d))(o, 0, 2, 1, 3).reshape(B, Sq, Hq * Dh) @ wo

    def _B_ref(x, k_cache, v_cache, wq, wo):
        B, Sq, D = x.shape
        Hq, Dh = 32, 128
        Hkv, Sk = k_cache.shape[1], k_cache.shape[2]
        W = min(4096, max(256, Sk // 4))
        rep = Hq // Hkv
        q = (lambda x, *d: x.permute(*d))((x @ wq).reshape(B, Sq, Hq, Dh), 0, 2, 1, 3)
        k = (lambda x, n, axis: torch.repeat_interleave(x, n, dim=axis))(k_cache[:, :, Sk - W:, :], rep, axis=1)
        v = (lambda x, n, axis: torch.repeat_interleave(x, n, dim=axis))(v_cache[:, :, Sk - W:, :], rep, axis=1)
        scores = torch.einsum("bhqd,bhkd->bhqk", q, k) * (Dh ** -0.5)
        p = _softmax(scores, axis=-1)
        o = torch.einsum("bhqk,bhkd->bhqd", p, v)
        return (lambda x, *d: x.permute(*d))(o, 0, 2, 1, 3).reshape(B, Sq, Hq * Dh) @ wo

    x = A_x
    x = x + _A_ref(_layernorm(x, axis=-1), A_k_cache, A_v_cache, A_wq, A_wo)
    x = x + _B_ref(_layernorm(x, axis=-1), B_k_cache, B_v_cache, B_wq, B_wo)
    x = x + _A_ref(_layernorm(x, axis=-1), A_k_cache, A_v_cache, A_wq, A_wo)
    x = x + _B_ref(_layernorm(x, axis=-1), B_k_cache, B_v_cache, B_wq, B_wo)
    return x
```

```asm
; @launch grid=(256,1,1) block=(256,1,1) lds=163840
.amdgcn_target "amdgcn-amd-amdhsa--gfx950"
.text
.globl interleave_layers__sliding_block_cached__sliding_block_cached__decode_kernel
.p2align 8
.type interleave_layers__sliding_block_cached__sliding_block_cached__decode_kernel,@function
interleave_layers__sliding_block_cached__sliding_block_cached__decode_kernel:
s_cmp_ge_u32 s2, 256
s_cbranch_scc1 L_END
s_load_dwordx8 s[88:95], s[0:1], 0
s_load_dwordx2 s[96:97], s[0:1], 32
s_load_dwordx2 s[98:99], s[0:1], 96
s_load_dwordx4 s[16:19], s[0:1], 48
s_load_dwordx4 s[32:35], s[0:1], 64
s_load_dwordx4 s[52:55], s[0:1], 80
v_lshrrev_b32 v1, 6, v0
v_and_b32 v0, 63, v0
v_readfirstlane_b32 s3, v1
s_and_b32 s56, s2, 7
s_lshr_b32 s57, s2, 3
s_lshr_b32 s7, s57, 3
s_lshl_b32 s58, s56, 2
s_add_u32 s58, s58, s7
s_and_b32 s59, s57, 7
v_lshlrev_b32 v1, 4, v0
s_lshr_b32 s7, s59, 2
s_lshl_b32 s7, s7, 5
s_add_u32 s7, s7, s58
s_lshl_b32 s7, s7, 21
s_and_b32 s76, s59, 3
s_lshl_b32 s76, s76, 17
s_add_u32 s7, s7, s76
s_lshl_b32 s76, s3, 10
s_add_u32 s7, s7, s76
s_add_u32 s83, s7, 1572864
s_mul_i32 s74, s3, 23552
v_lshrrev_b32 v44, 3, v0
v_and_b32 v45, 7, v0
v_lshlrev_b32 v45, 4, v45
v_lshl_add_u32 v17, v44, 13, v45
v_lshl_add_u32 v18, v44, 10, v45
s_and_b32 s7, s59, 3
s_lshl_b32 s7, s7, 2
s_add_u32 s7, s7, s3
s_lshl_b32 s78, s7, 18
s_lshl_b32 s77, s58, 8
s_lshr_b32 s76, s59, 2
s_lshl_b32 s76, s76, 7
s_add_u32 s77, s77, s76
s_lshl_b32 s82, s3, 12
s_add_u32 s82, s82, 94208
s_getreg_b32 s84, hwreg(HW_REG_XCC_ID, 0, 4)
s_and_b32 s84, s84, 7
s_waitcnt lgkmcnt(0)
s_add_u32 s8, s90, s83
s_addc_u32 s9, s91, 0
s_mov_b32 s10, 131072
s_mov_b32 s11, 0x20000
s_add_u32 s24, s94, s77
s_addc_u32 s25, s95, 0
s_sub_u32 s26, 4194304, s77
s_mov_b32 s27, 0x20000
s_add_u32 s32, s32, s77
s_addc_u32 s33, s33, 0
s_mov_b32 s75, s26
s_mov_b32 s40, s98
s_mov_b32 s41, s99
s_mov_b32 s42, 3145728
s_mov_b32 s43, 0x20000
s_cmp_lg_u32 s3, 3
s_cbranch_scc1 NOCLR_1
v_mov_b32 v48, -1
v_mov_b32 v49, -1
v_mov_b32 v50, -1
v_mov_b32 v51, -1
s_mul_i32 s7, s2, 8192
buffer_store_dwordx4 v[48:51], v1, s[40:43], s7 offen offset:0 sc1
buffer_store_dwordx4 v[48:51], v1, s[40:43], s7 offen offset:1024 sc1
buffer_store_dwordx4 v[48:51], v1, s[40:43], s7 offen offset:2048 sc1
buffer_store_dwordx4 v[48:51], v1, s[40:43], s7 offen offset:3072 sc1
s_add_u32 s7, s7, 4096
buffer_store_dwordx4 v[48:51], v1, s[40:43], s7 offen offset:0 sc1
buffer_store_dwordx4 v[48:51], v1, s[40:43], s7 offen offset:1024 sc1
buffer_store_dwordx4 v[48:51], v1, s[40:43], s7 offen offset:2048 sc1
buffer_store_dwordx4 v[48:51], v1, s[40:43], s7 offen offset:3072 sc1
s_lshl_b32 s7, s84, 3
s_lshl_b64 s[76:77], 1, s7
v_mov_b32 v48, s76
v_mov_b32 v49, s77
s_lshr_b32 s7, s56, 1
s_lshl_b32 s7, s7, 6
s_and_b32 s76, s56, 1
s_lshl_b32 s76, s76, 3
s_add_u32 s7, s7, s76
v_mov_b32 v50, s7
s_waitcnt vmcnt(0)
s_mov_b64 exec, 1
global_atomic_add_x2 v50, v[48:49], s[54:55]
s_mov_b64 exec, -1
NOCLR_1:
v_mov_b32 v48, 161828
v_mov_b32 v49, 0
s_cmp_eq_u32 s3, 0
s_cselect_b64 exec, 1, 0
ds_write_b32 v48, v49
s_mov_b64 exec, -1
s_add_u32 s7, s78, 0
s_add_u32 m0, s82, 0
s_nop 0
buffer_load_dwordx4 v17, s[24:27], s7 offen nt lds
s_add_u32 s7, s78, 65536
s_add_u32 m0, s82, 1024
s_nop 0
buffer_load_dwordx4 v17, s[24:27], s7 offen nt lds
s_add_u32 s7, s78, 131072
s_add_u32 m0, s82, 2048
s_nop 0
buffer_load_dwordx4 v17, s[24:27], s7 offen nt lds
s_add_u32 s7, s78, 196608
s_add_u32 m0, s82, 3072
s_nop 0
buffer_load_dwordx4 v17, s[24:27], s7 offen nt lds
s_mov_b32 s44, s88
s_mov_b32 s45, s89
s_mov_b32 s46, 2048
s_mov_b32 s47, 0x20000
v_lshrrev_b32 v52, 4, v0
v_and_b32 v53, 1, v0
v_lshlrev_b32 v53, 10, v53
v_lshl_add_u32 v52, v52, 4, v53
s_and_b32 s7, s59, 3
s_lshl_b32 s7, s7, 8
v_add_u32 v52, s7, v52
v_mov_b32 v24, 0x3f803f80
v_mov_b32 v25, 0x3f803f80
v_mov_b32 v26, 0x3f803f80
v_mov_b32 v27, 0x3f803f80
v_mov_b32 v28, 0x3f803f80
v_mov_b32 v29, 0x3f803f80
v_mov_b32 v30, 0x3f803f80
v_mov_b32 v31, 0x3f803f80
v_mov_b32 v32, 0x3f803f80
v_mov_b32 v33, 0x3f803f80
v_mov_b32 v34, 0x3f803f80
v_mov_b32 v35, 0x3f803f80
v_mov_b32 v36, 0x3f803f80
v_mov_b32 v37, 0x3f803f80
v_mov_b32 v38, 0x3f803f80
v_mov_b32 v39, 0x3f803f80
s_mov_b32 exec_lo, 0x00030003
s_mov_b32 exec_hi, 0x00030003
buffer_load_dwordx4 v[24:27], v52, s[44:47], 0 offen offset:0
buffer_load_dwordx4 v[28:31], v52, s[44:47], 0 offen offset:64
buffer_load_dwordx4 v[32:35], v52, s[44:47], 0 offen offset:128
buffer_load_dwordx4 v[36:39], v52, s[44:47], 0 offen offset:192
s_mov_b64 exec, -1
s_mov_b32 s7, 0
buffer_load_dwordx4 a[0:3], v1, s[8:11], s7 offen nt
s_mov_b32 s7, 4096
buffer_load_dwordx4 a[4:7], v1, s[8:11], s7 offen nt
s_mov_b32 s7, 8192
buffer_load_dwordx4 a[8:11], v1, s[8:11], s7 offen nt
s_mov_b32 s7, 12288
buffer_load_dwordx4 a[12:15], v1, s[8:11], s7 offen nt
s_mov_b32 s7, 16384
buffer_load_dwordx4 a[16:19], v1, s[8:11], s7 offen nt
s_mov_b32 s7, 20480
buffer_load_dwordx4 a[20:23], v1, s[8:11], s7 offen nt
s_mov_b32 s7, 24576
buffer_load_dwordx4 a[24:27], v1, s[8:11], s7 offen nt
s_mov_b32 s7, 28672
buffer_load_dwordx4 a[28:31], v1, s[8:11], s7 offen nt
s_mov_b32 s86, s98
s_mov_b32 s87, s99
s_add_u32 s12, s92, s83
s_addc_u32 s13, s93, 0
s_mov_b32 s14, 131072
s_mov_b32 s15, 0x20000
s_add_u32 s20, s18, s83
s_addc_u32 s21, s19, 0
s_mov_b32 s22, 131072
s_mov_b32 s23, 0x20000
s_add_u32 s16, s16, s83
s_addc_u32 s17, s17, 0
s_mov_b32 s18, 131072
s_mov_b32 s19, 0x20000
s_lshl_b32 s7, s58, 17
s_lshl_b32 s76, s59, 7
s_add_u32 s7, s7, s76
s_add_u32 s28, s96, s7
s_addc_u32 s29, s97, 0
s_sub_u32 s30, 4194304, s7
s_mov_b32 s31, 0x20000
s_add_u32 s36, s34, s7
s_addc_u32 s37, s35, 0
s_sub_u32 s38, 4194304, s7
s_mov_b32 s39, 0x20000
s_mov_b32 s34, s75
s_mov_b32 s35, 0x20000
s_mov_b32 s76, s52
s_mov_b32 s77, s53
s_mov_b32 s52, s54
s_mov_b32 s53, s55
s_mov_b32 s54, s76
s_mov_b32 s55, s77
s_mov_b32 s51, 0x20000
s_mov_b32 s48, s98
s_mov_b32 s49, s99
s_mov_b32 s50, 0
s_mov_b32 s68, 0x30003
s_mov_b32 s69, 0x30003
s_mov_b32 s70, 0x11111111
s_mov_b32 s71, 0x11111111
s_mov_b32 s72, 0x110011
s_mov_b32 s73, 0x110011
s_mov_b32 s100, 0xff00ff
s_mov_b32 s101, 0xff00ff
s_mov_b32 s88, 0x22222222
s_mov_b32 s89, 0x22222222
s_cmp_eq_u32 s3, 0
s_cselect_b32 s90, 3, 0
s_mov_b32 s91, 0
s_mov_b32 s80, 0x3e0293ee
s_mov_b32 s4, 0
s_mov_b32 s5, 0
s_mov_b32 s6, 0
s_mov_b32 s85, 32768
s_mov_b32 s93, 512
s_lshl_b32 s79, s3, 15
s_lshl_b32 s60, s58, 12
s_add_u32 s60, s60, 294912
s_lshr_b32 s7, s59, 2
s_lshl_b32 s76, s7, 11
s_add_u32 s61, s60, s76
s_lshl_b32 s64, s58, 6
s_add_u32 s64, s64, 18432
s_and_b32 s76, s59, 3
s_lshl_b32 s76, s76, 4
s_add_u32 s92, s64, s76
s_lshl_b32 s7, s7, 3
s_add_u32 s64, s64, s7
s_lshl_b32 s62, s58, 11
s_add_u32 s62, s62, 98304
s_lshl_b32 s65, s58, 5
s_add_u32 s65, s65, 16384
s_lshl_b32 s7, s59, 2
s_add_u32 s63, s65, s7
s_lshl_b32 s67, s57, 12
s_add_u32 s67, s67, 163840
s_lshl_b32 s7, s59, 2
s_add_u32 s7, s7, s3
s_lshl_b32 s7, s7, 12
s_lshl_b32 s76, s58, 7
s_add_u32 s7, s7, s76
s_add_u32 s66, s7, 163840
s_lshl_b32 s81, s56, 11
s_add_u32 s81, s81, 0
v_lshlrev_b32 v11, 2, v0
v_lshrrev_b32 v44, 4, v0
v_and_b32 v45, 15, v0
v_lshlrev_b32 v46, 2, v44
v_xor_b32 v46, v46, v45
v_lshlrev_b32 v46, 4, v46
v_lshl_add_u32 v16, v44, 8, v46
v_bfe_u32 v46, v0, 2, 2
v_bfe_u32 v47, v0, 1, 1
v_lshl_add_u32 v47, v44, 1, v47
v_lshlrev_b32 v48, 2, v46
v_xor_b32 v47, v47, v48
v_lshlrev_b32 v47, 4, v47
v_lshl_add_u32 v47, v46, 8, v47
v_and_b32 v48, 1, v0
v_lshl_add_u32 v47, v48, 3, v47
v_add_u32 v3, s74, v47
v_xor_b32 v4, 0x80, v3
v_lshl_add_u32 v47, v44, 3, v46
v_lshlrev_b32 v47, 7, v47
v_and_b32 v48, 3, v0
v_lshl_add_u32 v47, v48, 3, v47
s_lshl_b32 s7, s3, 5
s_add_u32 s7, s7, 94208
v_add_u32 v2, s7, v47
v_and_b32 v46, 1, v45
v_lshlrev_b32 v46, 4, v46
v_lshl_add_u32 v46, v44, 5, v46
s_and_b32 s7, s59, 3
s_lshl_b32 s7, s7, 9
v_add_u32 v5, s7, v46
v_lshlrev_b32 v6, 4, v48
v_lshrrev_b32 v46, 2, v0
v_lshlrev_b32 v46, 5, v46
v_add_u32 v21, 161856, v46
v_and_b32 v46, 7, v45
v_lshlrev_b32 v8, 2, v46
v_lshlrev_b32 v46, 4, v46
v_lshl_add_u32 v7, v44, 7, v46
v_lshrrev_b32 v46, 2, v0
v_lshlrev_b32 v46, 7, v46
v_lshl_add_u32 v46, v48, 2, v46
s_lshl_b32 s7, s59, 4
v_add_u32 v23, s7, v46
v_bfe_u32 v46, v0, 2, 1
v_lshlrev_b32 v47, 6, v46
v_lshl_add_u32 v22, v44, 4, v47
v_lshlrev_b32 v47, 10, v46
v_lshl_add_u32 v47, v48, 3, v47
s_lshl_b32 s7, s57, 5
v_add_u32 v50, s7, v47
v_lshlrev_b32 v46, 4, v46
v_lshrrev_b32 v47, 1, v48
v_lshl_add_u32 v46, v47, 5, v46
v_and_b32 v47, 1, v48
v_lshl_add_u32 v46, v47, 3, v46
s_lshl_b32 s7, s57, 6
v_add_u32 v9, s7, v46
v_lshlrev_b32 v46, 1, v45
v_and_b32 v47, 1, v44
v_add_u32 v46, v46, v47
v_lshlrev_b32 v46, 10, v46
v_lshrrev_b32 v47, 1, v44
v_lshl_add_u32 v46, v47, 6, v46
s_lshr_b32 s7, s59, 2
s_lshl_b32 s7, s7, 3
s_lshl_b32 s76, s3, 1
s_add_u32 s7, s7, s76
s_lshl_b32 s7, s7, 2
s_and_b32 s76, s59, 3
s_add_u32 s7, s7, s76
s_lshl_b32 s7, s7, 4
v_add_u32 v10, s7, v46
buffer_load_dwordx2 v[12:13], v50, s[44:47], 0 offen
s_branch S_START
L_LOOP:
s_mov_b64 exec, s[68:69]
buffer_load_dwordx4 v[24:27], v5, s[44:47], 0 offen offset:0 sc1
buffer_load_dwordx4 v[28:31], v5, s[44:47], 0 offen offset:128 sc1
buffer_load_dwordx4 v[32:35], v5, s[44:47], 0 offen offset:256 sc1
buffer_load_dwordx4 v[36:39], v5, s[44:47], 0 offen offset:384 sc1
s_mov_b64 exec, -1
s_waitcnt vmcnt(0)
C_D:
s_waitcnt lgkmcnt(0)
v_mfma_f32_16x16x32_bf16 v[56:59], v[40:43], v[24:27], 0
v_mfma_f32_16x16x32_bf16 v[56:59], v[44:47], v[28:31], v[56:59]
v_mfma_f32_16x16x32_bf16 v[56:59], v[48:51], v[32:35], v[56:59]
v_mfma_f32_16x16x32_bf16 v[56:59], v[52:55], v[36:39], v[56:59]
v_mfma_f32_16x16x32_bf16 v[60:63], v[24:27], v[24:27], 0
v_mfma_f32_16x16x32_bf16 v[60:63], v[28:31], v[28:31], v[60:63]
v_mfma_f32_16x16x32_bf16 v[60:63], v[32:35], v[32:35], v[60:63]
v_mfma_f32_16x16x32_bf16 v[60:63], v[36:39], v[36:39], v[60:63]
v_max3_u32 v69, v24, v25, v26
v_max3_u32 v70, v27, v28, v29
v_max3_u32 v69, v69, v30, v31
v_max3_u32 v70, v70, v32, v33
v_max3_u32 v69, v69, v34, v35
v_max3_u32 v70, v70, v36, v37
v_max3_u32 v69, v69, v38, v39
v_max_u32 v69, v69, v70
v_cmp_eq_u32 vcc, -1, v69
s_and_b64 vcc, vcc, exec
s_cbranch_scc1 Y_D
K_D:
v_cmp_eq_u32 vcc, 1, v0
v_lshlrev_b32 v64, 3, v0
s_mov_b64 exec, s[68:69]
s_cmp_lg_u32 s6, 0
s_cbranch_scc1 L_PFq
buffer_store_dwordx4 v[56:59], v10, s[40:43], s60 offen sc1
s_branch L_PEq
L_PFq:
buffer_store_dwordx4 v[56:59], v10, s[40:43], s60 offen
L_PEq:
s_mov_b64 exec, s[90:91]
v_cndmask_b32 v60, v60, v61, vcc
v_mov_b32 v61, v62
s_cmp_lg_u32 s6, 0
s_cbranch_scc1 L_PFs
buffer_store_dwordx2 v[60:61], v64, s[40:43], s92 offen sc1
s_branch L_PEs
L_PFs:
buffer_store_dwordx2 v[60:61], v64, s[40:43], s92 offen
L_PEs:
s_mov_b64 exec, -1
s_cmp_lt_u32 s4, 2
s_cbranch_scc1 S_A0
R_A0:
buffer_load_dwordx4 v[24:27], v1, s[40:43], s61 offen offset:0 sc1
buffer_load_dwordx4 v[28:31], v1, s[40:43], s61 offen offset:1024 sc1
buffer_load_dwordx2 v[32:33], v6, s[40:43], s64 offen sc1
ds_read_b128 v[34:37], v21
ds_read_b128 v[38:41], v21 offset:16
s_waitcnt vmcnt(0)
C_A:
v_max3_u32 v69, v24, v25, v26
v_max3_u32 v70, v27, v28, v29
v_max3_u32 v69, v69, v30, v31
v_max3_u32 v70, v70, v32, v33
v_max_u32 v69, v69, v70
v_cmp_eq_u32 vcc, -1, v69
s_and_b64 vcc, vcc, exec
s_cbranch_scc1 Y_A
K_A:
v_add_f32_dpp v33, v33, v33 quad_perm:[1,0,3,2] row_mask:0xf bank_mask:0xf
v_add_f32_dpp v32, v32, v32 quad_perm:[1,0,3,2] row_mask:0xf bank_mask:0xf
v_add_f32_dpp v24, v24, v24 quad_perm:[1,0,3,2] row_mask:0xf bank_mask:0xf
v_add_f32_dpp v25, v25, v25 quad_perm:[1,0,3,2] row_mask:0xf bank_mask:0xf
v_add_f32_dpp v33, v33, v33 quad_perm:[2,3,0,1] row_mask:0xf bank_mask:0xf
v_add_f32_dpp v32, v32, v32 quad_perm:[2,3,0,1] row_mask:0xf bank_mask:0xf
v_add_f32_dpp v26, v26, v26 quad_perm:[1,0,3,2] row_mask:0xf bank_mask:0xf
v_add_f32_dpp v27, v27, v27 quad_perm:[1,0,3,2] row_mask:0xf bank_mask:0xf
v_mul_f32 v33, 0x3b000000, v33
v_mul_f32 v32, 0x3b000000, v32
v_add_f32_dpp v28, v28, v28 quad_perm:[1,0,3,2] row_mask:0xf bank_mask:0xf
v_add_f32_dpp v29, v29, v29 quad_perm:[1,0,3,2] row_mask:0xf bank_mask:0xf
v_fma_f32 v32, -v33, v33, v32
v_add_f32_dpp v30, v30, v30 quad_perm:[1,0,3,2] row_mask:0xf bank_mask:0xf
v_max_f32 v32, 0, v32
v_add_f32_dpp v31, v31, v31 quad_perm:[1,0,3,2] row_mask:0xf bank_mask:0xf
v_add_f32 v32, 0x3727c5ac, v32
v_add_f32_dpp v24, v24, v24 quad_perm:[2,3,0,1] row_mask:0xf bank_mask:0xf
v_rsq_f32 v32, v32
v_add_f32_dpp v25, v25, v25 quad_perm:[2,3,0,1] row_mask:0xf bank_mask:0xf
v_add_f32_dpp v26, v26, v26 quad_perm:[2,3,0,1] row_mask:0xf bank_mask:0xf
v_add_f32_dpp v27, v27, v27 quad_perm:[2,3,0,1] row_mask:0xf bank_mask:0xf
v_add_f32_dpp v28, v28, v28 quad_perm:[2,3,0,1] row_mask:0xf bank_mask:0xf
v_add_f32_dpp v29, v29, v29 quad_perm:[2,3,0,1] row_mask:0xf bank_mask:0xf
v_add_f32_dpp v30, v30, v30 quad_perm:[2,3,0,1] row_mask:0xf bank_mask:0xf
v_add_f32_dpp v31, v31, v31 quad_perm:[2,3,0,1] row_mask:0xf bank_mask:0xf
s_waitcnt lgkmcnt(0)
v_fma_f32 v24, -v33, v34, v24
v_fma_f32 v25, -v33, v35, v25
v_fma_f32 v26, -v33, v36, v26
v_fma_f32 v27, -v33, v37, v27
v_fma_f32 v28, -v33, v38, v28
v_fma_f32 v29, -v33, v39, v29
v_fma_f32 v30, -v33, v40, v30
v_fma_f32 v31, -v33, v41, v31
v_mul_f32 v24, v24, v32
v_mul_f32 v25, v25, v32
v_mul_f32 v26, v26, v32
v_mul_f32 v27, v27, v32
v_mul_f32 v28, v28, v32
v_mul_f32 v29, v29, v32
v_mul_f32 v30, v30, v32
v_mul_f32 v31, v31, v32
v_cvt_pk_bf16_f32 v76, v24, v25
v_cvt_pk_bf16_f32 v77, v26, v27
v_cvt_pk_bf16_f32 v78, v28, v29
v_cvt_pk_bf16_f32 v79, v30, v31
s_cmp_eq_u32 s4, 1
s_cbranch_scc1 S_Q1
R_Q1:
L_QK:
s_bitcmp1_b32 s4, 0
s_cbranch_scc1 QK_B
v_mfma_f32_4x4x4_16b_bf16 v[24:27], v[76:77], a[0:1], 0 cbsz:3 abid:0
ds_read_b64_tr_b16 v[44:45], v3 offset:0
v_mfma_f32_4x4x4_16b_bf16 v[28:31], v[76:77], a[32:33], 0 cbsz:3 abid:0
ds_read_b64_tr_b16 v[46:47], v4 offset:0
v_mfma_f32_4x4x4_16b_bf16 v[24:27], v[78:79], a[2:3], v[24:27] cbsz:3 abid:0
ds_read_b64_tr_b16 v[48:49], v3 offset:1024
v_mfma_f32_4x4x4_16b_bf16 v[28:31], v[78:79], a[34:35], v[28:31] cbsz:3 abid:0
ds_read_b64_tr_b16 v[50:51], v4 offset:1024
v_mfma_f32_4x4x4_16b_bf16 v[24:27], v[76:77], a[4:5], v[24:27] cbsz:3 abid:1
ds_read_b64_tr_b16 v[52:53], v3 offset:2048
v_mfma_f32_4x4x4_16b_bf16 v[28:31], v[76:77], a[36:37], v[28:31] cbsz:3 abid:1
ds_read_b64_tr_b16 v[54:55], v4 offset:2048
v_mfma_f32_4x4x4_16b_bf16 v[24:27], v[78:79], a[6:7], v[24:27] cbsz:3 abid:1
ds_read_b64_tr_b16 v[56:57], v3 offset:3072
v_mfma_f32_4x4x4_16b_bf16 v[28:31], v[78:79], a[38:39], v[28:31] cbsz:3 abid:1
ds_read_b64_tr_b16 v[58:59], v4 offset:3072
v_mfma_f32_4x4x4_16b_bf16 v[24:27], v[76:77], a[8:9], v[24:27] cbsz:3 abid:2
ds_read_b64_tr_b16 v[60:61], v3 offset:4096
v_mfma_f32_4x4x4_16b_bf16 v[28:31], v[76:77], a[40:41], v[28:31] cbsz:3 abid:2
ds_read_b64_tr_b16 v[62:63], v4 offset:4096
v_mfma_f32_4x4x4_16b_bf16 v[24:27], v[78:79], a[10:11], v[24:27] cbsz:3 abid:2
v_mfma_f32_4x4x4_16b_bf16 v[28:31], v[78:79], a[42:43], v[28:31] cbsz:3 abid:2
s_nop 0
v_mfma_f32_4x4x4_16b_bf16 v[24:27], v[76:77], a[12:13], v[24:27] cbsz:3 abid:3
v_mfma_f32_4x4x4_16b_bf16 v[28:31], v[76:77], a[44:45], v[28:31] cbsz:3 abid:3
s_nop 0
v_mfma_f32_4x4x4_16b_bf16 v[24:27], v[78:79], a[14:15], v[24:27] cbsz:3 abid:3
v_mfma_f32_4x4x4_16b_bf16 v[28:31], v[78:79], a[46:47], v[28:31] cbsz:3 abid:3
s_nop 0
v_mfma_f32_4x4x4_16b_bf16 v[24:27], v[76:77], a[16:17], v[24:27] cbsz:3 abid:4
v_mfma_f32_4x4x4_16b_bf16 v[28:31], v[76:77], a[48:49], v[28:31] cbsz:3 abid:4
s_nop 0
v_mfma_f32_4x4x4_16b_bf16 v[24:27], v[78:79], a[18:19], v[24:27] cbsz:3 abid:4
v_mfma_f32_4x4x4_16b_bf16 v[28:31], v[78:79], a[50:51], v[28:31] cbsz:3 abid:4
s_nop 0
v_mfma_f32_4x4x4_16b_bf16 v[24:27], v[76:77], a[20:21], v[24:27] cbsz:3 abid:5
v_mfma_f32_4x4x4_16b_bf16 v[28:31], v[76:77], a[52:53], v[28:31] cbsz:3 abid:5
s_nop 0
v_mfma_f32_4x4x4_16b_bf16 v[24:27], v[78:79], a[22:23], v[24:27] cbsz:3 abid:5
v_mfma_f32_4x4x4_16b_bf16 v[28:31], v[78:79], a[54:55], v[28:31] cbsz:3 abid:5
s_nop 0
v_mfma_f32_4x4x4_16b_bf16 v[24:27], v[76:77], a[24:25], v[24:27] cbsz:3 abid:6
v_mfma_f32_4x4x4_16b_bf16 v[28:31], v[76:77], a[56:57], v[28:31] cbsz:3 abid:6
s_nop 0
v_mfma_f32_4x4x4_16b_bf16 v[24:27], v[78:79], a[26:27], v[24:27] cbsz:3 abid:6
v_mfma_f32_4x4x4_16b_bf16 v[28:31], v[78:79], a[58:59], v[28:31] cbsz:3 abid:6
s_nop 0
v_mfma_f32_4x4x4_16b_bf16 v[24:27], v[76:77], a[28:29], v[24:27] cbsz:3 abid:7
v_mfma_f32_4x4x4_16b_bf16 v[28:31], v[76:77], a[60:61], v[28:31] cbsz:3 abid:7
s_nop 0
v_mfma_f32_4x4x4_16b_bf16 v[24:27], v[78:79], a[30:31], v[24:27] cbsz:3 abid:7
v_mfma_f32_4x4x4_16b_bf16 v[28:31], v[78:79], a[62:63], v[28:31] cbsz:3 abid:7
v_mfma_f32_4x4x4_16b_bf16 v[32:35], v[76:77], a[64:65], 0 cbsz:3 abid:0
v_mfma_f32_4x4x4_16b_bf16 v[36:39], v[76:77], a[96:97], 0 cbsz:3 abid:0
s_nop 0
v_mfma_f32_4x4x4_16b_bf16 v[32:35], v[78:79], a[66:67], v[32:35] cbsz:3 abid:0
v_mfma_f32_4x4x4_16b_bf16 v[36:39], v[78:79], a[98:99], v[36:39] cbsz:3 abid:0
v_permlane32_swap_b32 v24, v28
v_mfma_f32_4x4x4_16b_bf16 v[32:35], v[76:77], a[68:69], v[32:35] cbsz:3 abid:1
v_add_f32 v24, v24, v28
v_mfma_f32_4x4x4_16b_bf16 v[36:39], v[76:77], a[100:101], v[36:39] cbsz:3 abid:1
v_mfma_f32_4x4x4_16b_bf16 v[32:35], v[78:79], a[70:71], v[32:35] cbsz:3 abid:1
v_max_f32_dpp v25, v24, v24 row_ror:8 row_mask:0xf bank_mask:0xf
v_mfma_f32_4x4x4_16b_bf16 v[36:39], v[78:79], a[102:103], v[36:39] cbsz:3 abid:1
v_mfma_f32_4x4x4_16b_bf16 v[32:35], v[76:77], a[72:73], v[32:35] cbsz:3 abid:2
v_max_f32_dpp v25, v25, v25 row_ror:4 row_mask:0xf bank_mask:0xf
v_mfma_f32_4x4x4_16b_bf16 v[36:39], v[76:77], a[104:105], v[36:39] cbsz:3 abid:2
v_mfma_f32_4x4x4_16b_bf16 v[32:35], v[78:79], a[74:75], v[32:35] cbsz:3 abid:2
v_max_f32_dpp v25, v25, v25 row_ror:2 row_mask:0xf bank_mask:0xf
v_mfma_f32_4x4x4_16b_bf16 v[36:39], v[78:79], a[106:107], v[36:39] cbsz:3 abid:2
v_mfma_f32_4x4x4_16b_bf16 v[32:35], v[76:77], a[76:77], v[32:35] cbsz:3 abid:3
v_max_f32_dpp v25, v25, v25 row_ror:1 row_mask:0xf bank_mask:0xf
v_mfma_f32_4x4x4_16b_bf16 v[36:39], v[76:77], a[108:109], v[36:39] cbsz:3 abid:3
v_mov_b32 v26, v25
v_mfma_f32_4x4x4_16b_bf16 v[32:35], v[78:79], a[78:79], v[32:35] cbsz:3 abid:3
v_mfma_f32_4x4x4_16b_bf16 v[36:39], v[78:79], a[110:111], v[36:39] cbsz:3 abid:3
v_permlane16_swap_b32 v25, v26
v_mfma_f32_4x4x4_16b_bf16 v[32:35], v[76:77], a[80:81], v[32:35] cbsz:3 abid:4
v_max_f32 v25, v25, v26
v_mfma_f32_4x4x4_16b_bf16 v[36:39], v[76:77], a[112:113], v[36:39] cbsz:3 abid:4
v_mov_b32 v26, v25
v_mfma_f32_4x4x4_16b_bf16 v[32:35], v[78:79], a[82:83], v[32:35] cbsz:3 abid:4
v_mfma_f32_4x4x4_16b_bf16 v[36:39], v[78:79], a[114:115], v[36:39] cbsz:3 abid:4
v_permlane32_swap_b32 v25, v26
v_mfma_f32_4x4x4_16b_bf16 v[32:35], v[76:77], a[84:85], v[32:35] cbsz:3 abid:5
v_max_f32 v25, v25, v26
v_mfma_f32_4x4x4_16b_bf16 v[36:39], v[76:77], a[116:117], v[36:39] cbsz:3 abid:5
v_mul_f32 v25, s80, v25
v_mfma_f32_4x4x4_16b_bf16 v[32:35], v[78:79], a[86:87], v[32:35] cbsz:3 abid:5
v_fma_f32 v24, v24, s80, -v25
v_mfma_f32_4x4x4_16b_bf16 v[36:39], v[78:79], a[118:119], v[36:39] cbsz:3 abid:5
v_exp_f32 v24, v24
v_mfma_f32_4x4x4_16b_bf16 v[32:35], v[76:77], a[88:89], v[32:35] cbsz:3 abid:6
v_mfma_f32_4x4x4_16b_bf16 v[36:39], v[76:77], a[120:121], v[36:39] cbsz:3 abid:6
v_mov_b32_dpp v26, v24 quad_perm:[1,1,3,3] row_mask:0xf bank_mask:0xf
v_mfma_f32_4x4x4_16b_bf16 v[32:35], v[78:79], a[90:91], v[32:35] cbsz:3 abid:6
v_cvt_pk_bf16_f32 v26, v24, v26
v_mfma_f32_4x4x4_16b_bf16 v[36:39], v[78:79], a[122:123], v[36:39] cbsz:3 abid:6
v_mfma_f32_4x4x4_16b_bf16 v[32:35], v[76:77], a[92:93], v[32:35] cbsz:3 abid:7
v_mov_b32_dpp v27, v26 quad_perm:[2,2,2,2] row_mask:0xf bank_mask:0xf
v_mfma_f32_4x4x4_16b_bf16 v[36:39], v[76:77], a[124:125], v[36:39] cbsz:3 abid:7
v_cndmask_b32 v40, 0, v26, s[70:71]
v_mfma_f32_4x4x4_16b_bf16 v[32:35], v[78:79], a[94:95], v[32:35] cbsz:3 abid:7
v_cndmask_b32 v41, 0, v27, s[70:71]
v_mfma_f32_4x4x4_16b_bf16 v[36:39], v[78:79], a[126:127], v[36:39] cbsz:3 abid:7
s_branch QK_E
QK_B:
v_mfma_f32_4x4x4_16b_bf16 v[24:27], v[76:77], a[128:129], 0 cbsz:3 abid:0
ds_read_b64_tr_b16 v[44:45], v3 offset:10240
v_mfma_f32_4x4x4_16b_bf16 v[28:31], v[76:77], a[160:161], 0 cbsz:3 abid:0
ds_read_b64_tr_b16 v[46:47], v4 offset:10240
v_mfma_f32_4x4x4_16b_bf16 v[24:27], v[78:79], a[130:131], v[24:27] cbsz:3 abid:0
ds_read_b64_tr_b16 v[48:49], v3 offset:11264
v_mfma_f32_4x4x4_16b_bf16 v[28:31], v[78:79], a[162:163], v[28:31] cbsz:3 abid:0
ds_read_b64_tr_b16 v[50:51], v4 offset:11264
v_mfma_f32_4x4x4_16b_bf16 v[24:27], v[76:77], a[132:133], v[24:27] cbsz:3 abid:1
ds_read_b64_tr_b16 v[52:53], v3 offset:12288
v_mfma_f32_4x4x4_16b_bf16 v[28:31], v[76:77], a[164:165], v[28:31] cbsz:3 abid:1
ds_read_b64_tr_b16 v[54:55], v4 offset:12288
v_mfma_f32_4x4x4_16b_bf16 v[24:27], v[78:79], a[134:135], v[24:27] cbsz:3 abid:1
ds_read_b64_tr_b16 v[56:57], v3 offset:13312
v_mfma_f32_4x4x4_16b_bf16 v[28:31], v[78:79], a[166:167], v[28:31] cbsz:3 abid:1
ds_read_b64_tr_b16 v[58:59], v4 offset:13312
v_mfma_f32_4x4x4_16b_bf16 v[24:27], v[76:77], a[136:137], v[24:27] cbsz:3 abid:2
ds_read_b64_tr_b16 v[60:61], v3 offset:14336
v_mfma_f32_4x4x4_16b_bf16 v[28:31], v[76:77], a[168:169], v[28:31] cbsz:3 abid:2
ds_read_b64_tr_b16 v[62:63], v4 offset:14336
v_mfma_f32_4x4x4_16b_bf16 v[24:27], v[78:79], a[138:139], v[24:27] cbsz:3 abid:2
v_mfma_f32_4x4x4_16b_bf16 v[28:31], v[78:79], a[170:171], v[28:31] cbsz:3 abid:2
s_nop 0
v_mfma_f32_4x4x4_16b_bf16 v[24:27], v[76:77], a[140:141], v[24:27] cbsz:3 abid:3
v_mfma_f32_4x4x4_16b_bf16 v[28:31], v[76:77], a[172:173], v[28:31] cbsz:3 abid:3
s_nop 0
v_mfma_f32_4x4x4_16b_bf16 v[24:27], v[78:79], a[142:143], v[24:27] cbsz:3 abid:3
v_mfma_f32_4x4x4_16b_bf16 v[28:31], v[78:79], a[174:175], v[28:31] cbsz:3 abid:3
s_nop 0
v_mfma_f32_4x4x4_16b_bf16 v[24:27], v[76:77], a[144:145], v[24:27] cbsz:3 abid:4
v_mfma_f32_4x4x4_16b_bf16 v[28:31], v[76:77], a[176:177], v[28:31] cbsz:3 abid:4
s_nop 0
v_mfma_f32_4x4x4_16b_bf16 v[24:27], v[78:79], a[146:147], v[24:27] cbsz:3 abid:4
v_mfma_f32_4x4x4_16b_bf16 v[28:31], v[78:79], a[178:179], v[28:31] cbsz:3 abid:4
s_nop 0
v_mfma_f32_4x4x4_16b_bf16 v[24:27], v[76:77], a[148:149], v[24:27] cbsz:3 abid:5
v_mfma_f32_4x4x4_16b_bf16 v[28:31], v[76:77], a[180:181], v[28:31] cbsz:3 abid:5
s_nop 0
v_mfma_f32_4x4x4_16b_bf16 v[24:27], v[78:79], a[150:151], v[24:27] cbsz:3 abid:5
v_mfma_f32_4x4x4_16b_bf16 v[28:31], v[78:79], a[182:183], v[28:31] cbsz:3 abid:5
s_nop 0
v_mfma_f32_4x4x4_16b_bf16 v[24:27], v[76:77], a[152:153], v[24:27] cbsz:3 abid:6
v_mfma_f32_4x4x4_16b_bf16 v[28:31], v[76:77], a[184:185], v[28:31] cbsz:3 abid:6
s_nop 0
v_mfma_f32_4x4x4_16b_bf16 v[24:27], v[78:79], a[154:155], v[24:27] cbsz:3 abid:6
v_mfma_f32_4x4x4_16b_bf16 v[28:31], v[78:79], a[186:187], v[28:31] cbsz:3 abid:6
s_nop 0
v_mfma_f32_4x4x4_16b_bf16 v[24:27], v[76:77], a[156:157], v[24:27] cbsz:3 abid:7
v_mfma_f32_4x4x4_16b_bf16 v[28:31], v[76:77], a[188:189], v[28:31] cbsz:3 abid:7
s_nop 0
v_mfma_f32_4x4x4_16b_bf16 v[24:27], v[78:79], a[158:159], v[24:27] cbsz:3 abid:7
v_mfma_f32_4x4x4_16b_bf16 v[28:31], v[78:79], a[190:191], v[28:31] cbsz:3 abid:7
v_mfma_f32_4x4x4_16b_bf16 v[32:35], v[76:77], a[192:193], 0 cbsz:3 abid:0
v_mfma_f32_4x4x4_16b_bf16 v[36:39], v[76:77], a[224:225], 0 cbsz:3 abid:0
s_nop 0
v_mfma_f32_4x4x4_16b_bf16 v[32:35], v[78:79], a[194:195], v[32:35] cbsz:3 abid:0
v_mfma_f32_4x4x4_16b_bf16 v[36:39], v[78:79], a[226:227], v[36:39] cbsz:3 abid:0
v_permlane32_swap_b32 v24, v28
v_mfma_f32_4x4x4_16b_bf16 v[32:35], v[76:77], a[196:197], v[32:35] cbsz:3 abid:1
v_add_f32 v24, v24, v28
v_mfma_f32_4x4x4_16b_bf16 v[36:39], v[76:77], a[228:229], v[36:39] cbsz:3 abid:1
v_mfma_f32_4x4x4_16b_bf16 v[32:35], v[78:79], a[198:199], v[32:35] cbsz:3 abid:1
v_max_f32_dpp v25, v24, v24 row_ror:8 row_mask:0xf bank_mask:0xf
v_mfma_f32_4x4x4_16b_bf16 v[36:39], v[78:79], a[230:231], v[36:39] cbsz:3 abid:1
v_mfma_f32_4x4x4_16b_bf16 v[32:35], v[76:77], a[200:201], v[32:35] cbsz:3 abid:2
v_max_f32_dpp v25, v25, v25 row_ror:4 row_mask:0xf bank_mask:0xf
v_mfma_f32_4x4x4_16b_bf16 v[36:39], v[76:77], a[232:233], v[36:39] cbsz:3 abid:2
v_mfma_f32_4x4x4_16b_bf16 v[32:35], v[78:79], a[202:203], v[32:35] cbsz:3 abid:2
v_max_f32_dpp v25, v25, v25 row_ror:2 row_mask:0xf bank_mask:0xf
v_mfma_f32_4x4x4_16b_bf16 v[36:39], v[78:79], a[234:235], v[36:39] cbsz:3 abid:2
v_mfma_f32_4x4x4_16b_bf16 v[32:35], v[76:77], a[204:205], v[32:35] cbsz:3 abid:3
v_max_f32_dpp v25, v25, v25 row_ror:1 row_mask:0xf bank_mask:0xf
v_mfma_f32_4x4x4_16b_bf16 v[36:39], v[76:77], a[236:237], v[36:39] cbsz:3 abid:3
v_mov_b32 v26, v25
v_mfma_f32_4x4x4_16b_bf16 v[32:35], v[78:79], a[206:207], v[32:35] cbsz:3 abid:3
v_mfma_f32_4x4x4_16b_bf16 v[36:39], v[78:79], a[238:239], v[36:39] cbsz:3 abid:3
v_permlane16_swap_b32 v25, v26
v_mfma_f32_4x4x4_16b_bf16 v[32:35], v[76:77], a[208:209], v[32:35] cbsz:3 abid:4
v_max_f32 v25, v25, v26
v_mfma_f32_4x4x4_16b_bf16 v[36:39], v[76:77], a[240:241], v[36:39] cbsz:3 abid:4
v_mov_b32 v26, v25
v_mfma_f32_4x4x4_16b_bf16 v[32:35], v[78:79], a[210:211], v[32:35] cbsz:3 abid:4
v_mfma_f32_4x4x4_16b_bf16 v[36:39], v[78:79], a[242:243], v[36:39] cbsz:3 abid:4
v_permlane32_swap_b32 v25, v26
v_mfma_f32_4x4x4_16b_bf16 v[32:35], v[76:77], a[212:213], v[32:35] cbsz:3 abid:5
v_max_f32 v25, v25, v26
v_mfma_f32_4x4x4_16b_bf16 v[36:39], v[76:77], a[244:245], v[36:39] cbsz:3 abid:5
v_mul_f32 v25, s80, v25
v_mfma_f32_4x4x4_16b_bf16 v[32:35], v[78:79], a[214:215], v[32:35] cbsz:3 abid:5
v_fma_f32 v24, v24, s80, -v25
v_mfma_f32_4x4x4_16b_bf16 v[36:39], v[78:79], a[246:247], v[36:39] cbsz:3 abid:5
v_exp_f32 v24, v24
v_mfma_f32_4x4x4_16b_bf16 v[32:35], v[76:77], a[216:217], v[32:35] cbsz:3 abid:6
v_mfma_f32_4x4x4_16b_bf16 v[36:39], v[76:77], a[248:249], v[36:39] cbsz:3 abid:6
v_mov_b32_dpp v26, v24 quad_perm:[1,1,3,3] row_mask:0xf bank_mask:0xf
v_mfma_f32_4x4x4_16b_bf16 v[32:35], v[78:79], a[218:219], v[32:35] cbsz:3 abid:6
v_cvt_pk_bf16_f32 v26, v24, v26
v_mfma_f32_4x4x4_16b_bf16 v[36:39], v[78:79], a[250:251], v[36:39] cbsz:3 abid:6
v_mfma_f32_4x4x4_16b_bf16 v[32:35], v[76:77], a[220:221], v[32:35] cbsz:3 abid:7
v_mov_b32_dpp v27, v26 quad_perm:[2,2,2,2] row_mask:0xf bank_mask:0xf
v_mfma_f32_4x4x4_16b_bf16 v[36:39], v[76:77], a[252:253], v[36:39] cbsz:3 abid:7
v_cndmask_b32 v40, 0, v26, s[70:71]
v_mfma_f32_4x4x4_16b_bf16 v[32:35], v[78:79], a[222:223], v[32:35] cbsz:3 abid:7
v_cndmask_b32 v41, 0, v27, s[70:71]
v_mfma_f32_4x4x4_16b_bf16 v[36:39], v[78:79], a[254:255], v[36:39] cbsz:3 abid:7
QK_E:
s_cmp_lt_u32 s4, 2
s_cbranch_scc1 S_PV
R_PV:
s_bitcmp1_b32 s4, 0
s_cbranch_scc1 PV_B
v_mfma_f32_4x4x4_16b_bf16 v[64:67], v[40:41], v[80:81], 0 cbsz:4 abid:0
v_permlane32_swap_b32 v32, v36
v_mfma_f32_4x4x4_16b_bf16 v[68:71], v[40:41], v[82:83], 0 cbsz:4 abid:0
v_add_f32 v32, v32, v36
v_mfma_f32_4x4x4_16b_bf16 v[64:67], v[40:41], v[84:85], v[64:67] cbsz:4 abid:1
v_mfma_f32_4x4x4_16b_bf16 v[68:71], v[40:41], v[86:87], v[68:71] cbsz:4 abid:1
v_max_f32_dpp v33, v32, v32 row_ror:8 row_mask:0xf bank_mask:0xf
v_mfma_f32_4x4x4_16b_bf16 v[64:67], v[40:41], v[88:89], v[64:67] cbsz:4 abid:2
v_mfma_f32_4x4x4_16b_bf16 v[68:71], v[40:41], v[90:91], v[68:71] cbsz:4 abid:2
v_max_f32_dpp v33, v33, v33 row_ror:4 row_mask:0xf bank_mask:0xf
v_mfma_f32_4x4x4_16b_bf16 v[64:67], v[40:41], v[92:93], v[64:67] cbsz:4 abid:3
v_mfma_f32_4x4x4_16b_bf16 v[68:71], v[40:41], v[94:95], v[68:71] cbsz:4 abid:3
v_max_f32_dpp v33, v33, v33 row_ror:2 row_mask:0xf bank_mask:0xf
v_mfma_f32_4x4x4_16b_bf16 v[64:67], v[40:41], v[96:97], v[64:67] cbsz:4 abid:4
v_mfma_f32_4x4x4_16b_bf16 v[68:71], v[40:41], v[98:99], v[68:71] cbsz:4 abid:4
v_max_f32_dpp v33, v33, v33 row_ror:1 row_mask:0xf bank_mask:0xf
v_mfma_f32_4x4x4_16b_bf16 v[64:67], v[40:41], v[100:101], v[64:67] cbsz:4 abid:5
v_mov_b32 v34, v33
v_mfma_f32_4x4x4_16b_bf16 v[68:71], v[40:41], v[102:103], v[68:71] cbsz:4 abid:5
v_mfma_f32_4x4x4_16b_bf16 v[64:67], v[40:41], v[104:105], v[64:67] cbsz:4 abid:6
v_permlane16_swap_b32 v33, v34
v_mfma_f32_4x4x4_16b_bf16 v[68:71], v[40:41], v[106:107], v[68:71] cbsz:4 abid:6
v_max_f32 v33, v33, v34
v_mfma_f32_4x4x4_16b_bf16 v[64:67], v[40:41], v[108:109], v[64:67] cbsz:4 abid:7
v_mov_b32 v34, v33
v_mfma_f32_4x4x4_16b_bf16 v[68:71], v[40:41], v[110:111], v[68:71] cbsz:4 abid:7
v_mfma_f32_4x4x4_16b_bf16 v[64:67], v[40:41], v[112:113], v[64:67] cbsz:4 abid:8
v_permlane32_swap_b32 v33, v34
v_mfma_f32_4x4x4_16b_bf16 v[68:71], v[40:41], v[114:115], v[68:71] cbsz:4 abid:8
v_max_f32 v33, v33, v34
v_mfma_f32_4x4x4_16b_bf16 v[64:67], v[40:41], v[116:117], v[64:67] cbsz:4 abid:9
v_mul_f32 v33, s80, v33
v_mfma_f32_4x4x4_16b_bf16 v[68:71], v[40:41], v[118:119], v[68:71] cbsz:4 abid:9
v_fma_f32 v32, v32, s80, -v33
v_mfma_f32_4x4x4_16b_bf16 v[64:67], v[40:41], v[120:121], v[64:67] cbsz:4 abid:10
v_exp_f32 v32, v32
v_mfma_f32_4x4x4_16b_bf16 v[68:71], v[40:41], v[122:123], v[68:71] cbsz:4 abid:10
v_mfma_f32_4x4x4_16b_bf16 v[64:67], v[40:41], v[124:125], v[64:67] cbsz:4 abid:11
v_mov_b32_dpp v34, v32 quad_perm:[1,1,3,3] row_mask:0xf bank_mask:0xf
v_mfma_f32_4x4x4_16b_bf16 v[68:71], v[40:41], v[126:127], v[68:71] cbsz:4 abid:11
v_cvt_pk_bf16_f32 v34, v32, v34
v_mfma_f32_4x4x4_16b_bf16 v[64:67], v[40:41], v[128:129], v[64:67] cbsz:4 abid:12
v_mfma_f32_4x4x4_16b_bf16 v[68:71], v[40:41], v[130:131], v[68:71] cbsz:4 abid:12
v_mov_b32_dpp v35, v34 quad_perm:[2,2,2,2] row_mask:0xf bank_mask:0xf
v_mfma_f32_4x4x4_16b_bf16 v[64:67], v[40:41], v[132:133], v[64:67] cbsz:4 abid:13
v_mov_b32_dpp v37, v34 quad_perm:[0,0,0,0] row_mask:0xf bank_mask:0xf
v_mfma_f32_4x4x4_16b_bf16 v[68:71], v[40:41], v[134:135], v[68:71] cbsz:4 abid:13
v_cndmask_b32 v42, 0, v37, s[88:89]
v_mfma_f32_4x4x4_16b_bf16 v[64:67], v[40:41], v[136:137], v[64:67] cbsz:4 abid:14
v_cndmask_b32 v43, 0, v35, s[88:89]
v_mfma_f32_4x4x4_16b_bf16 v[68:71], v[40:41], v[138:139], v[68:71] cbsz:4 abid:14
v_mfma_f32_4x4x4_16b_bf16 v[64:67], v[40:41], v[140:141], v[64:67] cbsz:4 abid:15
s_nop 0
v_mfma_f32_4x4x4_16b_bf16 v[68:71], v[40:41], v[142:143], v[68:71] cbsz:4 abid:15
s_waitcnt lgkmcnt(0)
v_mfma_f32_4x4x4_16b_bf16 v[64:67], v[42:43], v[44:45], v[64:67] cbsz:4 abid:6
v_max_f32 v28, v25, v33
v_mfma_f32_4x4x4_16b_bf16 v[68:71], v[42:43], v[46:47], v[68:71] cbsz:4 abid:6
v_sub_f32 v26, v25, v28
v_mfma_f32_4x4x4_16b_bf16 v[64:67], v[42:43], v[48:49], v[64:67] cbsz:4 abid:7
v_sub_f32 v27, v33, v28
v_mfma_f32_4x4x4_16b_bf16 v[68:71], v[42:43], v[50:51], v[68:71] cbsz:4 abid:7
v_exp_f32 v26, v26
v_mfma_f32_4x4x4_16b_bf16 v[64:67], v[42:43], v[52:53], v[64:67] cbsz:4 abid:8
v_exp_f32 v27, v27
v_mfma_f32_4x4x4_16b_bf16 v[68:71], v[42:43], v[54:55], v[68:71] cbsz:4 abid:8
v_mul_f32 v29, v26, v24
v_mfma_f32_4x4x4_16b_bf16 v[64:67], v[42:43], v[56:57], v[64:67] cbsz:4 abid:9
v_fmac_f32 v29, v27, v32
v_mfma_f32_4x4x4_16b_bf16 v[68:71], v[42:43], v[58:59], v[68:71] cbsz:4 abid:9
v_mfma_f32_4x4x4_16b_bf16 v[64:67], v[42:43], v[60:61], v[64:67] cbsz:4 abid:10
v_add_f32_dpp v29, v29, v29 row_ror:8 row_mask:0xf bank_mask:0xf
v_mfma_f32_4x4x4_16b_bf16 v[68:71], v[42:43], v[62:63], v[68:71] cbsz:4 abid:10
v_mfma_f32_4x4x4_16b_bf16 v[64:67], v[42:43], v[144:145], v[64:67] cbsz:4 abid:0
ds_read_b64_tr_b16 v[44:45], v3 offset:5120
v_mfma_f32_4x4x4_16b_bf16 v[68:71], v[42:43], v[146:147], v[68:71] cbsz:4 abid:0
ds_read_b64_tr_b16 v[46:47], v4 offset:5120
v_mfma_f32_4x4x4_16b_bf16 v[64:67], v[42:43], v[148:149], v[64:67] cbsz:4 abid:1
ds_read_b64_tr_b16 v[48:49], v3 offset:6144
v_mfma_f32_4x4x4_16b_bf16 v[68:71], v[42:43], v[150:151], v[68:71] cbsz:4 abid:1
ds_read_b64_tr_b16 v[50:51], v4 offset:6144
v_mfma_f32_4x4x4_16b_bf16 v[64:67], v[42:43], v[152:153], v[64:67] cbsz:4 abid:2
ds_read_b64_tr_b16 v[52:53], v3 offset:7168
v_mfma_f32_4x4x4_16b_bf16 v[68:71], v[42:43], v[154:155], v[68:71] cbsz:4 abid:2
ds_read_b64_tr_b16 v[54:55], v4 offset:7168
v_mfma_f32_4x4x4_16b_bf16 v[64:67], v[42:43], v[156:157], v[64:67] cbsz:4 abid:3
ds_read_b64_tr_b16 v[56:57], v3 offset:8192
v_mfma_f32_4x4x4_16b_bf16 v[68:71], v[42:43], v[158:159], v[68:71] cbsz:4 abid:3
ds_read_b64_tr_b16 v[58:59], v4 offset:8192
v_mfma_f32_4x4x4_16b_bf16 v[64:67], v[42:43], v[160:161], v[64:67] cbsz:4 abid:4
ds_read_b64_tr_b16 v[60:61], v3 offset:9216
v_mfma_f32_4x4x4_16b_bf16 v[68:71], v[42:43], v[162:163], v[68:71] cbsz:4 abid:4
ds_read_b64_tr_b16 v[62:63], v4 offset:9216
v_mfma_f32_4x4x4_16b_bf16 v[64:67], v[42:43], v[164:165], v[64:67] cbsz:4 abid:5
v_add_f32_dpp v29, v29, v29 row_ror:4 row_mask:0xf bank_mask:0xf
v_mfma_f32_4x4x4_16b_bf16 v[68:71], v[42:43], v[166:167], v[68:71] cbsz:4 abid:5
s_waitcnt lgkmcnt(8)
v_mfma_f32_4x4x4_16b_bf16 v[64:67], v[42:43], v[44:45], v[64:67] cbsz:4 abid:11
v_add_f32_dpp v29, v29, v29 row_ror:2 row_mask:0xf bank_mask:0xf
v_mfma_f32_4x4x4_16b_bf16 v[68:71], v[42:43], v[46:47], v[68:71] cbsz:4 abid:11
s_waitcnt lgkmcnt(6)
v_mfma_f32_4x4x4_16b_bf16 v[64:67], v[42:43], v[48:49], v[64:67] cbsz:4 abid:12
v_add_f32_dpp v29, v29, v29 row_ror:1 row_mask:0xf bank_mask:0xf
v_mfma_f32_4x4x4_16b_bf16 v[68:71], v[42:43], v[50:51], v[68:71] cbsz:4 abid:12
v_mov_b32 v30, v29
s_waitcnt lgkmcnt(4)
v_mfma_f32_4x4x4_16b_bf16 v[64:67], v[42:43], v[52:53], v[64:67] cbsz:4 abid:13
v_permlane16_swap_b32 v29, v30
v_mfma_f32_4x4x4_16b_bf16 v[68:71], v[42:43], v[54:55], v[68:71] cbsz:4 abid:13
v_add_f32 v29, v29, v30
s_waitcnt lgkmcnt(2)
v_mfma_f32_4x4x4_16b_bf16 v[64:67], v[42:43], v[56:57], v[64:67] cbsz:4 abid:14
v_mov_b32 v30, v29
v_mfma_f32_4x4x4_16b_bf16 v[68:71], v[42:43], v[58:59], v[68:71] cbsz:4 abid:14
s_waitcnt lgkmcnt(0)
v_mfma_f32_4x4x4_16b_bf16 v[64:67], v[42:43], v[60:61], v[64:67] cbsz:4 abid:15
v_permlane32_swap_b32 v29, v30
v_mfma_f32_4x4x4_16b_bf16 v[68:71], v[42:43], v[62:63], v[68:71] cbsz:4 abid:15
v_add_f32 v29, v29, v30
s_branch PV_E
PV_B:
v_mfma_f32_4x4x4_16b_bf16 v[64:67], v[40:41], v[168:169], 0 cbsz:4 abid:0
v_permlane32_swap_b32 v32, v36
v_mfma_f32_4x4x4_16b_bf16 v[68:71], v[40:41], v[170:171], 0 cbsz:4 abid:0
v_add_f32 v32, v32, v36
v_mfma_f32_4x4x4_16b_bf16 v[64:67], v[40:41], v[172:173], v[64:67] cbsz:4 abid:1
v_mfma_f32_4x4x4_16b_bf16 v[68:71], v[40:41], v[174:175], v[68:71] cbsz:4 abid:1
v_max_f32_dpp v33, v32, v32 row_ror:8 row_mask:0xf bank_mask:0xf
v_mfma_f32_4x4x4_16b_bf16 v[64:67], v[40:41], v[176:177], v[64:67] cbsz:4 abid:2
v_mfma_f32_4x4x4_16b_bf16 v[68:71], v[40:41], v[178:179], v[68:71] cbsz:4 abid:2
v_max_f32_dpp v33, v33, v33 row_ror:4 row_mask:0xf bank_mask:0xf
v_mfma_f32_4x4x4_16b_bf16 v[64:67], v[40:41], v[180:181], v[64:67] cbsz:4 abid:3
v_mfma_f32_4x4x4_16b_bf16 v[68:71], v[40:41], v[182:183], v[68:71] cbsz:4 abid:3
v_max_f32_dpp v33, v33, v33 row_ror:2 row_mask:0xf bank_mask:0xf
v_mfma_f32_4x4x4_16b_bf16 v[64:67], v[40:41], v[184:185], v[64:67] cbsz:4 abid:4
v_mfma_f32_4x4x4_16b_bf16 v[68:71], v[40:41], v[186:187], v[68:71] cbsz:4 abid:4
v_max_f32_dpp v33, v33, v33 row_ror:1 row_mask:0xf bank_mask:0xf
v_mfma_f32_4x4x4_16b_bf16 v[64:67], v[40:41], v[188:189], v[64:67] cbsz:4 abid:5
v_mov_b32 v34, v33
v_mfma_f32_4x4x4_16b_bf16 v[68:71], v[40:41], v[190:191], v[68:71] cbsz:4 abid:5
v_mfma_f32_4x4x4_16b_bf16 v[64:67], v[40:41], v[192:193], v[64:67] cbsz:4 abid:6
v_permlane16_swap_b32 v33, v34
v_mfma_f32_4x4x4_16b_bf16 v[68:71], v[40:41], v[194:195], v[68:71] cbsz:4 abid:6
v_max_f32 v33, v33, v34
v_mfma_f32_4x4x4_16b_bf16 v[64:67], v[40:41], v[196:197], v[64:67] cbsz:4 abid:7
v_mov_b32 v34, v33
v_mfma_f32_4x4x4_16b_bf16 v[68:71], v[40:41], v[198:199], v[68:71] cbsz:4 abid:7
v_mfma_f32_4x4x4_16b_bf16 v[64:67], v[40:41], v[200:201], v[64:67] cbsz:4 abid:8
v_permlane32_swap_b32 v33, v34
v_mfma_f32_4x4x4_16b_bf16 v[68:71], v[40:41], v[202:203], v[68:71] cbsz:4 abid:8
v_max_f32 v33, v33, v34
v_mfma_f32_4x4x4_16b_bf16 v[64:67], v[40:41], v[204:205], v[64:67] cbsz:4 abid:9
v_mul_f32 v33, s80, v33
v_mfma_f32_4x4x4_16b_bf16 v[68:71], v[40:41], v[206:207], v[68:71] cbsz:4 abid:9
v_fma_f32 v32, v32, s80, -v33
v_mfma_f32_4x4x4_16b_bf16 v[64:67], v[40:41], v[208:209], v[64:67] cbsz:4 abid:10
v_exp_f32 v32, v32
v_mfma_f32_4x4x4_16b_bf16 v[68:71], v[40:41], v[210:211], v[68:71] cbsz:4 abid:10
v_mfma_f32_4x4x4_16b_bf16 v[64:67], v[40:41], v[212:213], v[64:67] cbsz:4 abid:11
v_mov_b32_dpp v34, v32 quad_perm:[1,1,3,3] row_mask:0xf bank_mask:0xf
v_mfma_f32_4x4x4_16b_bf16 v[68:71], v[40:41], v[214:215], v[68:71] cbsz:4 abid:11
v_cvt_pk_bf16_f32 v34, v32, v34
v_mfma_f32_4x4x4_16b_bf16 v[64:67], v[40:41], v[216:217], v[64:67] cbsz:4 abid:12
v_mfma_f32_4x4x4_16b_bf16 v[68:71], v[40:41], v[218:219], v[68:71] cbsz:4 abid:12
v_mov_b32_dpp v35, v34 quad_perm:[2,2,2,2] row_mask:0xf bank_mask:0xf
v_mfma_f32_4x4x4_16b_bf16 v[64:67], v[40:41], v[220:221], v[64:67] cbsz:4 abid:13
v_mov_b32_dpp v37, v34 quad_perm:[0,0,0,0] row_mask:0xf bank_mask:0xf
v_mfma_f32_4x4x4_16b_bf16 v[68:71], v[40:41], v[222:223], v[68:71] cbsz:4 abid:13
v_cndmask_b32 v42, 0, v37, s[88:89]
v_mfma_f32_4x4x4_16b_bf16 v[64:67], v[40:41], v[224:225], v[64:67] cbsz:4 abid:14
v_cndmask_b32 v43, 0, v35, s[88:89]
v_mfma_f32_4x4x4_16b_bf16 v[68:71], v[40:41], v[226:227], v[68:71] cbsz:4 abid:14
v_mfma_f32_4x4x4_16b_bf16 v[64:67], v[40:41], v[228:229], v[64:67] cbsz:4 abid:15
s_nop 0
v_mfma_f32_4x4x4_16b_bf16 v[68:71], v[40:41], v[230:231], v[68:71] cbsz:4 abid:15
s_waitcnt lgkmcnt(0)
v_mfma_f32_4x4x4_16b_bf16 v[64:67], v[42:43], v[44:45], v[64:67] cbsz:4 abid:6
v_max_f32 v28, v25, v33
v_mfma_f32_4x4x4_16b_bf16 v[68:71], v[42:43], v[46:47], v[68:71] cbsz:4 abid:6
v_sub_f32 v26, v25, v28
v_mfma_f32_4x4x4_16b_bf16 v[64:67], v[42:43], v[48:49], v[64:67] cbsz:4 abid:7
v_sub_f32 v27, v33, v28
v_mfma_f32_4x4x4_16b_bf16 v[68:71], v[42:43], v[50:51], v[68:71] cbsz:4 abid:7
v_exp_f32 v26, v26
v_mfma_f32_4x4x4_16b_bf16 v[64:67], v[42:43], v[52:53], v[64:67] cbsz:4 abid:8
v_exp_f32 v27, v27
v_mfma_f32_4x4x4_16b_bf16 v[68:71], v[42:43], v[54:55], v[68:71] cbsz:4 abid:8
v_mul_f32 v29, v26, v24
v_mfma_f32_4x4x4_16b_bf16 v[64:67], v[42:43], v[56:57], v[64:67] cbsz:4 abid:9
v_fmac_f32 v29, v27, v32
v_mfma_f32_4x4x4_16b_bf16 v[68:71], v[42:43], v[58:59], v[68:71] cbsz:4 abid:9
v_mfma_f32_4x4x4_16b_bf16 v[64:67], v[42:43], v[60:61], v[64:67] cbsz:4 abid:10
v_add_f32_dpp v29, v29, v29 row_ror:8 row_mask:0xf bank_mask:0xf
v_mfma_f32_4x4x4_16b_bf16 v[68:71], v[42:43], v[62:63], v[68:71] cbsz:4 abid:10
v_mfma_f32_4x4x4_16b_bf16 v[64:67], v[42:43], v[232:233], v[64:67] cbsz:4 abid:0
ds_read_b64_tr_b16 v[44:45], v3 offset:15360
v_mfma_f32_4x4x4_16b_bf16 v[68:71], v[42:43], v[234:235], v[68:71] cbsz:4 abid:0
ds_read_b64_tr_b16 v[46:47], v4 offset:15360
v_mfma_f32_4x4x4_16b_bf16 v[64:67], v[42:43], v[236:237], v[64:67] cbsz:4 abid:1
ds_read_b64_tr_b16 v[48:49], v3 offset:16384
v_mfma_f32_4x4x4_16b_bf16 v[68:71], v[42:43], v[238:239], v[68:71] cbsz:4 abid:1
ds_read_b64_tr_b16 v[50:51], v4 offset:16384
v_mfma_f32_4x4x4_16b_bf16 v[64:67], v[42:43], v[240:241], v[64:67] cbsz:4 abid:2
ds_read_b64_tr_b16 v[52:53], v3 offset:17408
v_mfma_f32_4x4x4_16b_bf16 v[68:71], v[42:43], v[242:243], v[68:71] cbsz:4 abid:2
ds_read_b64_tr_b16 v[54:55], v4 offset:17408
v_mfma_f32_4x4x4_16b_bf16 v[64:67], v[42:43], v[244:245], v[64:67] cbsz:4 abid:3
ds_read_b64_tr_b16 v[56:57], v3 offset:18432
v_mfma_f32_4x4x4_16b_bf16 v[68:71], v[42:43], v[246:247], v[68:71] cbsz:4 abid:3
ds_read_b64_tr_b16 v[58:59], v4 offset:18432
v_mfma_f32_4x4x4_16b_bf16 v[64:67], v[42:43], v[248:249], v[64:67] cbsz:4 abid:4
ds_read_b64_tr_b16 v[60:61], v3 offset:19456
v_mfma_f32_4x4x4_16b_bf16 v[68:71], v[42:43], v[250:251], v[68:71] cbsz:4 abid:4
ds_read_b64_tr_b16 v[62:63], v4 offset:19456
v_mfma_f32_4x4x4_16b_bf16 v[64:67], v[42:43], v[252:253], v[64:67] cbsz:4 abid:5
v_add_f32_dpp v29, v29, v29 row_ror:4 row_mask:0xf bank_mask:0xf
v_mfma_f32_4x4x4_16b_bf16 v[68:71], v[42:43], v[254:255], v[68:71] cbsz:4 abid:5
s_waitcnt lgkmcnt(8)
v_mfma_f32_4x4x4_16b_bf16 v[64:67], v[42:43], v[44:45], v[64:67] cbsz:4 abid:11
v_add_f32_dpp v29, v29, v29 row_ror:2 row_mask:0xf bank_mask:0xf
v_mfma_f32_4x4x4_16b_bf16 v[68:71], v[42:43], v[46:47], v[68:71] cbsz:4 abid:11
s_waitcnt lgkmcnt(6)
v_mfma_f32_4x4x4_16b_bf16 v[64:67], v[42:43], v[48:49], v[64:67] cbsz:4 abid:12
v_add_f32_dpp v29, v29, v29 row_ror:1 row_mask:0xf bank_mask:0xf
v_mfma_f32_4x4x4_16b_bf16 v[68:71], v[42:43], v[50:51], v[68:71] cbsz:4 abid:12
v_mov_b32 v30, v29
s_waitcnt lgkmcnt(4)
v_mfma_f32_4x4x4_16b_bf16 v[64:67], v[42:43], v[52:53], v[64:67] cbsz:4 abid:13
v_permlane16_swap_b32 v29, v30
v_mfma_f32_4x4x4_16b_bf16 v[68:71], v[42:43], v[54:55], v[68:71] cbsz:4 abid:13
v_add_f32 v29, v29, v30
s_waitcnt lgkmcnt(2)
v_mfma_f32_4x4x4_16b_bf16 v[64:67], v[42:43], v[56:57], v[64:67] cbsz:4 abid:14
v_mov_b32 v30, v29
v_mfma_f32_4x4x4_16b_bf16 v[68:71], v[42:43], v[58:59], v[68:71] cbsz:4 abid:14
s_waitcnt lgkmcnt(0)
v_mfma_f32_4x4x4_16b_bf16 v[64:67], v[42:43], v[60:61], v[64:67] cbsz:4 abid:15
v_permlane32_swap_b32 v29, v30
v_mfma_f32_4x4x4_16b_bf16 v[68:71], v[42:43], v[62:63], v[68:71] cbsz:4 abid:15
v_add_f32 v29, v29, v30
PV_E:
s_lshl_b32 s7, s3, 9
s_add_u32 s7, s7, 159744
v_add_u32 v40, s7, v11
s_lshl_b32 s7, s3, 3
s_add_u32 s7, s7, 161792
v_mov_b32 v41, s7
s_mov_b64 exec, 1
ds_write_b64 v41, v[28:29]
s_mov_b64 exec, -1
v_mul_f32 v30, v26, v64
v_mul_f32 v31, v26, v68
v_fmac_f32 v30, v27, v65
v_fmac_f32 v31, v27, v69
ds_write_b32 v40, v30
ds_write_b32 v40, v31 offset:256
v_lshlrev_b32 v42, 3, v0
v_add_u32 v42, 159744, v42
v_mov_b32 v43, 161792
s_waitcnt lgkmcnt(0)
s_barrier
ds_read_b64_tr_b16 v[56:57], v2 offset:16384
ds_read_b64_tr_b16 v[58:59], v2 offset:16896
ds_read_b64_tr_b16 v[60:61], v2 offset:20480
ds_read_b64_tr_b16 v[62:63], v2 offset:20992
ds_read_b64_tr_b16 v[64:65], v2 offset:24576
ds_read_b64_tr_b16 v[66:67], v2 offset:25088
ds_read_b64_tr_b16 v[68:69], v2 offset:28672
ds_read_b64_tr_b16 v[70:71], v2 offset:29184
s_cmp_lg_u32 s3, 0
s_cbranch_scc1 L_CBN
ds_read_b128 v[24:27], v43
ds_read_b128 v[28:31], v43 offset:16
ds_read_b64 v[32:33], v42 offset:0
ds_read_b64 v[34:35], v42 offset:512
ds_read_b64 v[36:37], v42 offset:1024
ds_read_b64 v[38:39], v42 offset:1536
s_waitcnt lgkmcnt(4)
v_max3_f32 v44, v24, v26, v28
v_max_f32 v44, v44, v30
v_sub_f32 v24, v24, v44
v_sub_f32 v26, v26, v44
v_sub_f32 v28, v28, v44
v_sub_f32 v30, v30, v44
v_exp_f32 v24, v24
v_exp_f32 v26, v26
v_exp_f32 v28, v28
v_exp_f32 v30, v30
v_mul_f32 v45, v24, v25
v_fmac_f32 v45, v26, v27
v_fmac_f32 v45, v28, v29
v_fmac_f32 v45, v30, v31
s_waitcnt lgkmcnt(0)
v_rcp_f32 v46, v45
v_mul_f32 v48, v24, v32
v_mul_f32 v49, v24, v33
v_fmac_f32 v48, v26, v34
v_fmac_f32 v49, v26, v35
v_fmac_f32 v48, v28, v36
v_fmac_f32 v49, v28, v37
v_fmac_f32 v48, v30, v38
v_fmac_f32 v49, v30, v39
v_log_f32 v47, v45
v_mul_f32 v48, v48, v46
v_mul_f32 v49, v49, v46
v_cvt_pk_bf16_f32 v48, v48, v49
v_add_f32 v47, v47, v44
v_mov_b32 v50, 0
s_cmp_lg_u32 s6, 0
s_cbranch_scc1 L_CBF
buffer_store_dword v48, v23, s[40:43], s62 offen sc1
s_mov_b64 exec, 1
buffer_store_dword v47, v50, s[40:43], s63 offen sc1
s_branch L_CBE
L_CBF:
buffer_store_dword v48, v23, s[40:43], s62 offen
s_mov_b64 exec, 1
buffer_store_dword v47, v50, s[40:43], s63 offen
L_CBE:
s_mov_b64 exec, -1
L_CB:
s_branch L_CBX
L_CBN:
s_sleep 10
L_CBX:
s_cmp_eq_u32 s4, 0
s_cbranch_scc1 S_B
R_B:
s_mov_b64 exec, s[100:101]
buffer_load_dwordx4 v[24:27], v7, s[40:43], s62 offen offset:0 sc1
buffer_load_dwordx4 v[28:31], v7, s[40:43], s62 offen offset:512 sc1
buffer_load_dwordx4 v[32:35], v7, s[40:43], s62 offen offset:1024 sc1
buffer_load_dwordx4 v[36:39], v7, s[40:43], s62 offen offset:1536 sc1
buffer_load_dword v40, v8, s[40:43], s65 offen sc1
s_mov_b64 exec, -1
s_add_u32 s7, s5, s81
s_add_u32 s44, s86, s7
s_addc_u32 s45, s87, 0
s_cmp_eq_u32 s4, 3
s_cselect_b32 s48, s54, s44
s_cselect_b32 s49, s55, s45
s_cselect_b64 vcc, -1, 0
s_cselect_b32 s7, s56, 0
s_cmp_eq_u32 s7, 0
s_cselect_b32 s50, 2048, 0
v_bfe_u32 v79, v0, 2, 1
v_lshlrev_b32 v79, 10, v79
v_and_b32 v78, 3, v0
v_lshl_add_u32 v79, v78, 3, v79
s_lshl_b32 s7, s57, 5
v_add_u32 v79, s7, v79
v_cndmask_b32 v79, v9, v79, vcc
s_waitcnt vmcnt(0)
C_B:
s_waitcnt lgkmcnt(0)
v_mfma_f32_16x16x32_bf16 v[48:51], v[56:59], v[24:27], 0
v_mfma_f32_16x16x32_bf16 v[48:51], v[60:63], v[28:31], v[48:51]
v_mfma_f32_16x16x32_bf16 v[48:51], v[64:67], v[32:35], v[48:51]
v_mfma_f32_16x16x32_bf16 v[48:51], v[68:71], v[36:39], v[48:51]
v_max3_u32 v46, v24, v25, v26
v_max3_u32 v47, v27, v28, v29
v_max3_u32 v46, v46, v30, v31
v_max3_u32 v47, v47, v32, v33
v_max3_u32 v46, v46, v34, v35
v_max3_u32 v47, v47, v36, v37
v_max3_u32 v46, v46, v38, v39
v_max3_u32 v46, v46, v47, v40
v_cmp_eq_u32 vcc, -1, v46
s_and_b64 vcc, vcc, s[100:101]
s_cbranch_scc1 Y_B
K_B:
v_mov_b32_dpp v41, v40 quad_perm:[1,0,3,2] row_mask:0xf bank_mask:0xf
v_max_f32 v41, v41, v40
s_nop 1
v_mov_b32_dpp v42, v41 quad_perm:[2,3,0,1] row_mask:0xf bank_mask:0xf
v_max_f32 v41, v41, v42
v_sub_f32 v41, v40, v41
v_exp_f32 v41, v41
s_nop 1
v_add_f32_dpp v42, v41, v41 quad_perm:[1,0,3,2] row_mask:0xf bank_mask:0xf
s_nop 1
v_add_f32_dpp v42, v42, v42 quad_perm:[2,3,0,1] row_mask:0xf bank_mask:0xf
v_rcp_f32 v42, v42
s_nop 0
v_mul_f32 v41, v41, v42
v_mul_f32 v48, v48, v41
v_mul_f32 v49, v49, v41
v_mul_f32 v50, v50, v41
v_mul_f32 v51, v51, v41
v_add_f32_dpp v48, v48, v48 quad_perm:[1,0,3,2] row_mask:0xf bank_mask:0xf
v_add_f32_dpp v49, v49, v49 quad_perm:[1,0,3,2] row_mask:0xf bank_mask:0xf
v_add_f32_dpp v50, v50, v50 quad_perm:[1,0,3,2] row_mask:0xf bank_mask:0xf
v_add_f32_dpp v51, v51, v51 quad_perm:[1,0,3,2] row_mask:0xf bank_mask:0xf
v_add_f32_dpp v48, v48, v48 quad_perm:[2,3,0,1] row_mask:0xf bank_mask:0xf
v_add_f32_dpp v49, v49, v49 quad_perm:[2,3,0,1] row_mask:0xf bank_mask:0xf
v_add_f32_dpp v50, v50, v50 quad_perm:[2,3,0,1] row_mask:0xf bank_mask:0xf
v_add_f32_dpp v51, v51, v51 quad_perm:[2,3,0,1] row_mask:0xf bank_mask:0xf
s_mov_b64 exec, s[72:73]
buffer_store_dwordx4 v[48:51], v22, s[40:43], s66 offen sc1
s_mov_b64 exec, -1
s_cmp_eq_u32 s4, 0
s_cbranch_scc1 S_YL
R_YL:
s_add_u32 s5, s5, 524288
s_add_u32 s60, s60, 524288
s_add_u32 s61, s61, 524288
s_add_u32 s62, s62, 524288
s_add_u32 s63, s63, 524288
s_add_u32 s64, s64, 524288
s_add_u32 s92, s92, 524288
s_add_u32 s65, s65, 524288
s_add_u32 s66, s66, 524288
v_add_u32 v2, s85, v2
s_sub_u32 s85, 0, s85
v_add_u32 v21, s93, v21
s_sub_u32 s93, 0, s93
ds_read_b64_tr_b16 v[40:41], v2 offset:0
ds_read_b64_tr_b16 v[42:43], v2 offset:512
ds_read_b64_tr_b16 v[44:45], v2 offset:4096
ds_read_b64_tr_b16 v[46:47], v2 offset:4608
ds_read_b64_tr_b16 v[48:49], v2 offset:8192
ds_read_b64_tr_b16 v[50:51], v2 offset:8704
ds_read_b64_tr_b16 v[52:53], v2 offset:12288
ds_read_b64_tr_b16 v[54:55], v2 offset:12800
v_mov_b32 v24, 0x3f803f80
v_mov_b32 v25, 0x3f803f80
v_mov_b32 v26, 0x3f803f80
v_mov_b32 v27, 0x3f803f80
v_mov_b32 v28, 0x3f803f80
v_mov_b32 v29, 0x3f803f80
v_mov_b32 v30, 0x3f803f80
v_mov_b32 v31, 0x3f803f80
v_mov_b32 v32, 0x3f803f80
v_mov_b32 v33, 0x3f803f80
v_mov_b32 v34, 0x3f803f80
v_mov_b32 v35, 0x3f803f80
v_mov_b32 v36, 0x3f803f80
v_mov_b32 v37, 0x3f803f80
v_mov_b32 v38, 0x3f803f80
v_mov_b32 v39, 0x3f803f80
s_cmp_lg_u32 s3, 0
s_cbranch_scc1 L_CXN
s_nop 15
s_nop 15
s_nop 15
s_nop 15
s_nop 15
s_nop 15
s_nop 15
s_nop 15
s_nop 15
s_nop 15
buffer_load_dwordx4 v[56:59], v1, s[40:43], s67 offen offset:0 sc1
buffer_load_dwordx4 v[60:63], v1, s[40:43], s67 offen offset:1024 sc1
buffer_load_dwordx4 v[64:67], v1, s[40:43], s67 offen offset:2048 sc1
buffer_load_dwordx4 v[68:71], v1, s[40:43], s67 offen offset:3072 sc1
s_waitcnt vmcnt(0)
C_C:
v_max3_u32 v72, v56, v57, v58
v_max3_u32 v73, v59, v60, v61
v_max3_u32 v72, v72, v62, v63
v_max3_u32 v73, v73, v64, v65
v_max3_u32 v72, v72, v66, v67
v_max3_u32 v73, v73, v68, v69
v_max3_u32 v72, v72, v70, v71
v_max_u32 v72, v72, v73
v_cmp_eq_u32 vcc, -1, v72
s_and_b64 vcc, vcc, exec
s_cbranch_scc1 Y_C
K_C:
v_add_f32 v56, v56, v60
v_add_f32 v57, v57, v61
v_add_f32 v58, v58, v62
v_add_f32 v59, v59, v63
v_add_f32 v64, v64, v68
v_add_f32 v65, v65, v69
v_add_f32 v66, v66, v70
v_add_f32 v67, v67, v71
v_add_f32 v56, v56, v64
v_add_f32 v57, v57, v65
v_add_f32 v58, v58, v66
v_add_f32 v59, v59, v67
v_add_f32_dpp v56, v56, v56 row_ror:8 row_mask:0xf bank_mask:0xf
v_add_f32_dpp v57, v57, v57 row_ror:8 row_mask:0xf bank_mask:0xf
v_add_f32_dpp v58, v58, v58 row_ror:8 row_mask:0xf bank_mask:0xf
v_add_f32_dpp v59, v59, v59 row_ror:8 row_mask:0xf bank_mask:0xf
v_mov_b32 v72, v56
v_mov_b32 v73, v57
v_mov_b32 v74, v58
v_mov_b32 v75, v59
v_permlane16_swap_b32 v56, v72
v_permlane16_swap_b32 v57, v73
v_permlane16_swap_b32 v58, v74
v_permlane16_swap_b32 v59, v75
v_add_f32 v56, v56, v72
v_add_f32 v57, v57, v73
v_add_f32 v58, v58, v74
v_add_f32 v59, v59, v75
v_mov_b32 v72, v56
v_mov_b32 v73, v57
v_mov_b32 v74, v58
v_mov_b32 v75, v59
v_permlane32_swap_b32 v56, v72
v_permlane32_swap_b32 v57, v73
v_permlane32_swap_b32 v58, v74
v_permlane32_swap_b32 v59, v75
v_add_f32 v56, v56, v72
v_add_f32 v57, v57, v73
v_add_f32 v58, v58, v74
v_add_f32 v59, v59, v75
v_cvt_pk_bf16_f32 v60, v56, v57
v_cvt_pk_bf16_f32 v61, v58, v59
v_lshlrev_b32 v62, 16, v60
v_and_b32 v63, 0xffff0000, v60
v_lshlrev_b32 v64, 16, v61
v_and_b32 v65, 0xffff0000, v61
v_add_f32 v62, v62, v12
v_add_f32 v63, v63, v13
v_add_f32 v64, v64, v14
v_add_f32 v65, v65, v15
v_cvt_pk_bf16_f32 v60, v62, v63
v_cvt_pk_bf16_f32 v61, v64, v65
s_mov_b64 exec, 0xff
s_cmp_lg_u32 s6, 0
s_cbranch_scc1 L_PFx
buffer_store_dwordx2 v[60:61], v79, s[48:51], 0 offen sc1
s_branch L_PEx
L_PFx:
buffer_store_dwordx2 v[60:61], v79, s[48:51], 0 offen
L_PEx:
s_mov_b64 exec, -1
v_lshlrev_b32 v12, 16, v60
v_and_b32 v13, 0xffff0000, v60
v_lshlrev_b32 v14, 16, v61
v_and_b32 v15, 0xffff0000, v61
s_cmp_eq_u32 s4, 0
s_cbranch_scc1 S_X1
R_X1:
L_CXN:
L_CX:
s_add_u32 s67, s67, 524288
s_add_u32 s4, s4, 1
s_cmp_lt_u32 s4, 4
s_cbranch_scc1 L_LOOP
L_END:
s_endpgm
Y_D:
s_nop 7
s_mov_b32 s75, 0
HL_2:
s_mov_b64 exec, s[68:69]
buffer_load_dwordx4 v[24:27], v5, s[44:47], 0 offen offset:0 sc1
buffer_load_dwordx4 v[28:31], v5, s[44:47], 0 offen offset:128 sc1
buffer_load_dwordx4 v[32:35], v5, s[44:47], 0 offen offset:256 sc1
buffer_load_dwordx4 v[36:39], v5, s[44:47], 0 offen offset:384 sc1
s_mov_b64 exec, -1
s_waitcnt vmcnt(0)
v_max3_u32 v69, v24, v25, v26
v_max3_u32 v70, v27, v28, v29
v_max3_u32 v69, v69, v30, v31
v_max3_u32 v70, v70, v32, v33
v_max3_u32 v69, v69, v34, v35
v_max3_u32 v70, v70, v36, v37
v_max3_u32 v69, v69, v38, v39
v_max_u32 v69, v69, v70
v_cmp_eq_u32 vcc, -1, v69
s_and_b64 vcc, vcc, exec
s_cbranch_scc0 HD_3
s_add_u32 s75, s75, 1
s_cmp_lt_u32 s75, 20000
s_cbranch_scc1 HL_2
s_nop 7
s_branch K_D
HD_3:
s_nop 7
s_branch C_D
Y_A:
s_nop 7
s_mov_b32 s75, 0
HL_4:
buffer_load_dwordx4 v[24:27], v1, s[40:43], s61 offen offset:0 sc1
buffer_load_dwordx4 v[28:31], v1, s[40:43], s61 offen offset:1024 sc1
buffer_load_dwordx2 v[32:33], v6, s[40:43], s64 offen sc1
s_waitcnt vmcnt(0)
v_max3_u32 v69, v24, v25, v26
v_max3_u32 v70, v27, v28, v29
v_max3_u32 v69, v69, v30, v31
v_max3_u32 v70, v70, v32, v33
v_max_u32 v69, v69, v70
v_cmp_eq_u32 vcc, -1, v69
s_and_b64 vcc, vcc, exec
s_cbranch_scc0 HD_5
s_add_u32 s75, s75, 1
s_cmp_lt_u32 s75, 20000
s_cbranch_scc1 HL_4
s_nop 7
s_branch K_A
HD_5:
s_nop 7
s_branch K_A
Y_B:
s_nop 7
s_mov_b32 s75, 0
HL_6:
s_mov_b64 exec, s[100:101]
buffer_load_dwordx4 v[24:27], v7, s[40:43], s62 offen offset:0 sc1
buffer_load_dwordx4 v[28:31], v7, s[40:43], s62 offen offset:512 sc1
buffer_load_dwordx4 v[32:35], v7, s[40:43], s62 offen offset:1024 sc1
buffer_load_dwordx4 v[36:39], v7, s[40:43], s62 offen offset:1536 sc1
buffer_load_dword v40, v8, s[40:43], s65 offen sc1
s_mov_b64 exec, -1
s_waitcnt vmcnt(0)
v_max3_u32 v46, v24, v25, v26
v_max3_u32 v47, v27, v28, v29
v_max3_u32 v46, v46, v30, v31
v_max3_u32 v47, v47, v32, v33
v_max3_u32 v46, v46, v34, v35
v_max3_u32 v47, v47, v36, v37
v_max3_u32 v46, v46, v38, v39
v_max3_u32 v46, v46, v47, v40
v_cmp_eq_u32 vcc, -1, v46
s_and_b64 vcc, vcc, s[100:101]
s_cbranch_scc0 HD_7
s_add_u32 s75, s75, 1
s_cmp_lt_u32 s75, 20000
s_cbranch_scc1 HL_6
s_nop 7
s_branch K_B
HD_7:
s_nop 7
s_branch C_B
Y_C:
s_nop 7
s_mov_b32 s75, 0
HL_8:
buffer_load_dwordx4 v[56:59], v1, s[40:43], s67 offen offset:0 sc1
buffer_load_dwordx4 v[60:63], v1, s[40:43], s67 offen offset:1024 sc1
buffer_load_dwordx4 v[64:67], v1, s[40:43], s67 offen offset:2048 sc1
buffer_load_dwordx4 v[68:71], v1, s[40:43], s67 offen offset:3072 sc1
s_waitcnt vmcnt(0)
v_max3_u32 v72, v56, v57, v58
v_max3_u32 v73, v59, v60, v61
v_max3_u32 v72, v72, v62, v63
v_max3_u32 v73, v73, v64, v65
v_max3_u32 v72, v72, v66, v67
v_max3_u32 v73, v73, v68, v69
v_max3_u32 v72, v72, v70, v71
v_max_u32 v72, v72, v73
v_cmp_eq_u32 vcc, -1, v72
s_and_b64 vcc, vcc, exec
s_cbranch_scc0 HD_9
s_add_u32 s75, s75, 1
s_cmp_lt_u32 s75, 20000
s_cbranch_scc1 HL_8
s_nop 7
s_branch K_C
HD_9:
s_nop 7
s_branch K_C
S_START:
s_nop 7
s_waitcnt vmcnt(12)
s_mov_b32 s7, 32768
buffer_load_dwordx4 a[32:35], v1, s[8:11], s7 offen nt
s_mov_b32 s7, 36864
buffer_load_dwordx4 a[36:39], v1, s[8:11], s7 offen nt
s_mov_b32 s7, 40960
buffer_load_dwordx4 a[40:43], v1, s[8:11], s7 offen nt
s_mov_b32 s7, 45056
buffer_load_dwordx4 a[44:47], v1, s[8:11], s7 offen nt
s_mov_b32 s7, 49152
buffer_load_dwordx4 a[48:51], v1, s[8:11], s7 offen nt
s_mov_b32 s7, 53248
buffer_load_dwordx4 a[52:55], v1, s[8:11], s7 offen nt
s_mov_b32 s7, 57344
buffer_load_dwordx4 a[56:59], v1, s[8:11], s7 offen nt
s_mov_b32 s7, 61440
buffer_load_dwordx4 a[60:63], v1, s[8:11], s7 offen nt
s_mov_b32 s7, 65536
buffer_load_dwordx4 a[64:67], v1, s[8:11], s7 offen nt
s_mov_b32 s7, 69632
buffer_load_dwordx4 a[68:71], v1, s[8:11], s7 offen nt
s_mov_b32 s7, 73728
buffer_load_dwordx4 a[72:75], v1, s[8:11], s7 offen nt
s_mov_b32 s7, 77824
buffer_load_dwordx4 a[76:79], v1, s[8:11], s7 offen nt
s_mov_b32 s7, 81920
buffer_load_dwordx4 a[80:83], v1, s[8:11], s7 offen nt
s_mov_b32 s7, 86016
buffer_load_dwordx4 a[84:87], v1, s[8:11], s7 offen nt
s_mov_b32 s7, 90112
buffer_load_dwordx4 a[88:91], v1, s[8:11], s7 offen nt
s_mov_b32 s7, 94208
buffer_load_dwordx4 a[92:95], v1, s[8:11], s7 offen nt
s_cmp_lg_u32 s3, 0
s_cbranch_scc1 SCO_10
v_lshrrev_b32 v72, 1, v0
v_lshlrev_b32 v72, 6, v72
v_and_b32 v73, 1, v0
v_lshl_add_u32 v72, v73, 3, v72
s_mov_b32 s75, 0
SCL_11:
s_mov_b64 exec, 0xff
global_load_dwordx2 v[74:75], v72, s[52:53] sc1
s_mov_b64 exec, -1
s_waitcnt vmcnt(0)
v_sad_u8 v73, v74, 0, 0
v_sad_u8 v73, v75, 0, v73
v_cmp_ne_u32 vcc, 32, v73
s_and_b64 vcc, vcc, 0xff
s_cbranch_scc0 SCD_12
s_add_u32 s75, s75, 1
s_cmp_lt_u32 s75, 20000
s_cbranch_scc1 SCL_11
SCD_12:
v_readlane_b32 s76, v74, s56
v_readlane_b32 s77, v75, s56
s_lshl_b32 s7, s84, 3
s_lshr_b64 s[76:77], s[76:77], s7
s_and_b32 s76, s76, 0xff
s_cmp_eq_u32 s76, 32
s_cselect_b32 s76, 1, 0
v_mov_b32 v72, 161824
v_mov_b32 v73, s76
ds_write_b32 v72, v73
s_waitcnt lgkmcnt(0)
SCO_10:
s_barrier
v_mov_b32 v72, 161824
ds_read_b32 v73, v72
s_waitcnt lgkmcnt(0)
v_readfirstlane_b32 s6, v73
s_waitcnt vmcnt(25)
s_waitcnt vmcnt(16)
v_and_b32 v15, 0xffff0000, v13
v_lshlrev_b32 v14, 16, v13
v_and_b32 v13, 0xffff0000, v12
v_lshlrev_b32 v12, 16, v12
ds_read_b64_tr_b16 v[40:41], v2 offset:0
ds_read_b64_tr_b16 v[42:43], v2 offset:512
ds_read_b64_tr_b16 v[44:45], v2 offset:4096
ds_read_b64_tr_b16 v[46:47], v2 offset:4608
ds_read_b64_tr_b16 v[48:49], v2 offset:8192
ds_read_b64_tr_b16 v[50:51], v2 offset:8704
ds_read_b64_tr_b16 v[52:53], v2 offset:12288
ds_read_b64_tr_b16 v[54:55], v2 offset:12800
s_nop 7
s_branch C_D
S_A0:
s_nop 7
s_cmp_eq_u32 s4, 0
s_cbranch_scc0 S_A0_1
v_and_b32 v72, 0x7ff, v10
s_sub_u32 s7, s60, 294912
s_lshr_b32 s76, s58, 0
s_lshl_b32 s76, s58, 11
s_sub_u32 s7, s7, s76
s_add_u32 s7, s7, 32768
s_mov_b32 exec_lo, 0x00040004
s_mov_b32 exec_hi, 0x00040004
buffer_store_dwordx4 v[56:59], v72, s[40:43], s7 offen sc1
s_mov_b64 exec, -1
v_lshrrev_b32 v74, 4, v0
v_and_b32 v75, 15, v0
v_xor_b32 v75, v75, v74
v_lshlrev_b32 v75, 4, v75
v_lshl_add_u32 v72, v74, 8, v75
s_add_u32 s7, s74, 10240
v_add_u32 v72, s7, v72
v_and_b32 v74, 31, v0
v_lshrrev_b32 v75, 5, v0
v_lshlrev_b32 v75, 3, v75
v_and_b32 v73, 15, v0
v_xor_b32 v73, v73, v75
v_lshlrev_b32 v73, 4, v73
v_lshl_add_u32 v73, v74, 8, v73
v_add_u32 v73, s7, v73
ds_write_b128 v72, a[0:3] offset:0
v_xor_b32 v74, 64, v72
ds_write_b128 v74, a[4:7] offset:1024
v_xor_b32 v75, 128, v72
ds_write_b128 v75, a[8:11] offset:2048
v_xor_b32 v74, 192, v72
ds_write_b128 v74, a[12:15] offset:3072
ds_write_b128 v72, a[16:19] offset:4096
v_xor_b32 v74, 64, v72
ds_write_b128 v74, a[20:23] offset:5120
v_xor_b32 v75, 128, v72
ds_write_b128 v75, a[24:27] offset:6144
v_xor_b32 v74, 192, v72
ds_write_b128 v74, a[28:31] offset:7168
s_waitcnt lgkmcnt(0)
ds_read_b128 a[0:3], v73
v_xor_b32 v74, 16, v73
ds_read_b128 a[4:7], v74
v_xor_b32 v75, 32, v73
ds_read_b128 a[8:11], v75
v_xor_b32 v74, 48, v73
ds_read_b128 a[12:15], v74
v_xor_b32 v75, 64, v73
ds_read_b128 a[16:19], v75
v_xor_b32 v74, 80, v73
ds_read_b128 a[20:23], v74
v_xor_b32 v75, 96, v73
ds_read_b128 a[24:27], v75
v_xor_b32 v74, 112, v73
ds_read_b128 a[28:31], v74
s_waitcnt lgkmcnt(0)
s_waitcnt vmcnt(12)
s_mov_b32 s7, 98304
buffer_load_dwordx4 a[96:99], v1, s[8:11], s7 offen nt
s_mov_b32 s7, 102400
buffer_load_dwordx4 a[100:103], v1, s[8:11], s7 offen nt
s_mov_b32 s7, 106496
buffer_load_dwordx4 a[104:107], v1, s[8:11], s7 offen nt
s_mov_b32 s7, 110592
buffer_load_dwordx4 a[108:111], v1, s[8:11], s7 offen nt
s_waitcnt vmcnt(12)
s_mov_b32 s7, 114688
buffer_load_dwordx4 a[112:115], v1, s[8:11], s7 offen nt
s_mov_b32 s7, 118784
buffer_load_dwordx4 a[116:119], v1, s[8:11], s7 offen nt
s_mov_b32 s7, 122880
buffer_load_dwordx4 a[120:123], v1, s[8:11], s7 offen nt
s_mov_b32 s7, 126976
buffer_load_dwordx4 a[124:127], v1, s[8:11], s7 offen nt
v_lshrrev_b32 v74, 4, v0
v_and_b32 v75, 15, v0
v_xor_b32 v75, v75, v74
v_lshlrev_b32 v75, 4, v75
v_lshl_add_u32 v72, v74, 8, v75
s_add_u32 s7, s74, 10240
v_add_u32 v72, s7, v72
v_and_b32 v74, 31, v0
v_lshrrev_b32 v75, 5, v0
v_lshlrev_b32 v75, 3, v75
v_and_b32 v73, 15, v0
v_xor_b32 v73, v73, v75
v_lshlrev_b32 v73, 4, v73
v_lshl_add_u32 v73, v74, 8, v73
v_add_u32 v73, s7, v73
ds_write_b128 v72, a[32:35] offset:0
v_xor_b32 v74, 64, v72
ds_write_b128 v74, a[36:39] offset:1024
v_xor_b32 v75, 128, v72
ds_write_b128 v75, a[40:43] offset:2048
v_xor_b32 v74, 192, v72
ds_write_b128 v74, a[44:47] offset:3072
ds_write_b128 v72, a[48:51] offset:4096
v_xor_b32 v74, 64, v72
ds_write_b128 v74, a[52:55] offset:5120
v_xor_b32 v75, 128, v72
ds_write_b128 v75, a[56:59] offset:6144
v_xor_b32 v74, 192, v72
ds_write_b128 v74, a[60:63] offset:7168
s_waitcnt lgkmcnt(0)
ds_read_b128 a[32:35], v73
v_xor_b32 v74, 16, v73
ds_read_b128 a[36:39], v74
v_xor_b32 v75, 32, v73
ds_read_b128 a[40:43], v75
v_xor_b32 v74, 48, v73
ds_read_b128 a[44:47], v74
v_xor_b32 v75, 64, v73
ds_read_b128 a[48:51], v75
v_xor_b32 v74, 80, v73
ds_read_b128 a[52:55], v74
v_xor_b32 v75, 96, v73
ds_read_b128 a[56:59], v75
v_xor_b32 v74, 112, v73
ds_read_b128 a[60:63], v74
s_waitcnt lgkmcnt(0)
s_waitcnt vmcnt(12)
s_mov_b32 s7, 0
buffer_load_dwordx4 v[80:83], v1, s[12:15], s7 offen nt
s_mov_b32 s7, 4096
buffer_load_dwordx4 v[84:87], v1, s[12:15], s7 offen nt
s_mov_b32 s7, 8192
buffer_load_dwordx4 v[88:91], v1, s[12:15], s7 offen nt
s_mov_b32 s7, 12288
buffer_load_dwordx4 v[92:95], v1, s[12:15], s7 offen nt
s_waitcnt vmcnt(12)
s_add_u32 s7, s79, 0
s_add_u32 m0, s82, 16384
s_nop 0
buffer_load_dwordx4 v18, s[28:31], s7 offen nt lds
s_mov_b32 s7, 16384
buffer_load_dwordx4 v[96:99], v1, s[12:15], s7 offen nt
s_mov_b32 s7, 20480
buffer_load_dwordx4 v[100:103], v1, s[12:15], s7 offen nt
s_mov_b32 s7, 24576
buffer_load_dwordx4 v[104:107], v1, s[12:15], s7 offen nt
v_lshrrev_b32 v74, 4, v0
v_and_b32 v75, 15, v0
v_xor_b32 v75, v75, v74
v_lshlrev_b32 v75, 4, v75
v_lshl_add_u32 v72, v74, 8, v75
s_add_u32 s7, s74, 10240
v_add_u32 v72, s7, v72
v_and_b32 v74, 31, v0
v_lshrrev_b32 v75, 5, v0
v_lshlrev_b32 v75, 3, v75
v_and_b32 v73, 15, v0
v_xor_b32 v73, v73, v75
v_lshlrev_b32 v73, 4, v73
v_lshl_add_u32 v73, v74, 8, v73
v_add_u32 v73, s7, v73
ds_write_b128 v72, a[64:67] offset:0
v_xor_b32 v74, 64, v72
ds_write_b128 v74, a[68:71] offset:1024
v_xor_b32 v75, 128, v72
ds_write_b128 v75, a[72:75] offset:2048
v_xor_b32 v74, 192, v72
ds_write_b128 v74, a[76:79] offset:3072
ds_write_b128 v72, a[80:83] offset:4096
v_xor_b32 v74, 64, v72
ds_write_b128 v74, a[84:87] offset:5120
v_xor_b32 v75, 128, v72
ds_write_b128 v75, a[88:91] offset:6144
v_xor_b32 v74, 192, v72
ds_write_b128 v74, a[92:95] offset:7168
s_waitcnt lgkmcnt(0)
ds_read_b128 a[64:67], v73
v_xor_b32 v74, 16, v73
ds_read_b128 a[68:71], v74
v_xor_b32 v75, 32, v73
ds_read_b128 a[72:75], v75
v_xor_b32 v74, 48, v73
ds_read_b128 a[76:79], v74
v_xor_b32 v75, 64, v73
ds_read_b128 a[80:83], v75
v_xor_b32 v74, 80, v73
ds_read_b128 a[84:87], v74
v_xor_b32 v75, 96, v73
ds_read_b128 a[88:91], v75
v_xor_b32 v74, 112, v73
ds_read_b128 a[92:95], v74
s_waitcnt lgkmcnt(0)
s_waitcnt vmcnt(12)
s_add_u32 s7, s79, 8192
s_add_u32 m0, s82, 17408
s_nop 0
buffer_load_dwordx4 v18, s[28:31], s7 offen nt lds
s_mov_b32 s7, 28672
buffer_load_dwordx4 v[108:111], v1, s[12:15], s7 offen nt
s_mov_b32 s7, 32768
buffer_load_dwordx4 v[112:115], v1, s[12:15], s7 offen nt
s_mov_b32 s7, 36864
buffer_load_dwordx4 v[116:119], v1, s[12:15], s7 offen nt
s_waitcnt vmcnt(12)
s_add_u32 s7, s79, 16384
s_add_u32 m0, s82, 18432
s_nop 0
buffer_load_dwordx4 v18, s[28:31], s7 offen nt lds
s_mov_b32 s7, 40960
buffer_load_dwordx4 v[120:123], v1, s[12:15], s7 offen nt
s_mov_b32 s7, 45056
buffer_load_dwordx4 v[124:127], v1, s[12:15], s7 offen nt
s_mov_b32 s7, 49152
buffer_load_dwordx4 v[128:131], v1, s[12:15], s7 offen nt
v_lshrrev_b32 v74, 4, v0
v_and_b32 v75, 15, v0
v_xor_b32 v75, v75, v74
v_lshlrev_b32 v75, 4, v75
v_lshl_add_u32 v72, v74, 8, v75
s_add_u32 s7, s74, 10240
v_add_u32 v72, s7, v72
v_and_b32 v74, 31, v0
v_lshrrev_b32 v75, 5, v0
v_lshlrev_b32 v75, 3, v75
v_and_b32 v73, 15, v0
v_xor_b32 v73, v73, v75
v_lshlrev_b32 v73, 4, v73
v_lshl_add_u32 v73, v74, 8, v73
v_add_u32 v73, s7, v73
ds_write_b128 v72, a[96:99] offset:0
v_xor_b32 v74, 64, v72
ds_write_b128 v74, a[100:103] offset:1024
v_xor_b32 v75, 128, v72
ds_write_b128 v75, a[104:107] offset:2048
v_xor_b32 v74, 192, v72
ds_write_b128 v74, a[108:111] offset:3072
ds_write_b128 v72, a[112:115] offset:4096
v_xor_b32 v74, 64, v72
ds_write_b128 v74, a[116:119] offset:5120
v_xor_b32 v75, 128, v72
ds_write_b128 v75, a[120:123] offset:6144
v_xor_b32 v74, 192, v72
ds_write_b128 v74, a[124:127] offset:7168
s_waitcnt lgkmcnt(0)
ds_read_b128 a[96:99], v73
v_xor_b32 v74, 16, v73
ds_read_b128 a[100:103], v74
v_xor_b32 v75, 32, v73
ds_read_b128 a[104:107], v75
v_xor_b32 v74, 48, v73
ds_read_b128 a[108:111], v74
v_xor_b32 v75, 64, v73
ds_read_b128 a[112:115], v75
v_xor_b32 v74, 80, v73
ds_read_b128 a[116:119], v74
v_xor_b32 v75, 96, v73
ds_read_b128 a[120:123], v75
v_xor_b32 v74, 112, v73
ds_read_b128 a[124:127], v74
s_waitcnt lgkmcnt(0)
s_sub_u32 s7, s60, 294912
s_lshl_b32 s76, s58, 11
s_sub_u32 s7, s7, s76
s_add_u32 s7, s7, 32768
buffer_load_dwordx4 v[44:47], v1, s[40:43], s7 offen offset:0 sc1
buffer_load_dwordx4 v[48:51], v1, s[40:43], s7 offen offset:1024 sc1
buffer_load_dwordx4 v[24:27], v1, s[40:43], s61 offen offset:0 sc1
buffer_load_dwordx4 v[28:31], v1, s[40:43], s61 offen offset:1024 sc1
buffer_load_dwordx2 v[32:33], v6, s[40:43], s64 offen sc1
s_waitcnt vmcnt(12)
s_add_u32 s7, s79, 24576
s_add_u32 m0, s82, 19456
s_nop 0
buffer_load_dwordx4 v18, s[28:31], s7 offen nt lds
s_mov_b32 s7, 53248
buffer_load_dwordx4 v[132:135], v1, s[12:15], s7 offen nt
s_add_u32 s7, s78, 0
s_add_u32 m0, s82, 32768
s_nop 0
buffer_load_dwordx4 v17, s[32:35], s7 offen nt lds
s_mov_b32 s7, 57344
buffer_load_dwordx4 v[136:139], v1, s[12:15], s7 offen nt
s_add_u32 s7, s74, 20480
v_add_u32 v72, s7, v16
ds_write_b128 v72, v[80:83] offset:0
ds_write_b128 v72, v[84:87] offset:1024
ds_write_b128 v72, v[88:91] offset:2048
s_waitcnt lgkmcnt(0)
ds_read_b64_tr_b16 v[80:81], v3 offset:20480
ds_read_b64_tr_b16 v[82:83], v4 offset:20480
ds_read_b64_tr_b16 v[84:85], v3 offset:21504
ds_read_b64_tr_b16 v[86:87], v4 offset:21504
ds_read_b64_tr_b16 v[88:89], v3 offset:22528
ds_read_b64_tr_b16 v[90:91], v4 offset:22528
s_waitcnt lgkmcnt(0)
s_add_u32 s7, s74, 20480
v_add_u32 v72, s7, v16
ds_write_b128 v72, v[92:95] offset:0
ds_write_b128 v72, v[96:99] offset:1024
ds_write_b128 v72, v[100:103] offset:2048
s_waitcnt lgkmcnt(0)
ds_read_b64_tr_b16 v[92:93], v3 offset:20480
ds_read_b64_tr_b16 v[94:95], v4 offset:20480
ds_read_b64_tr_b16 v[96:97], v3 offset:21504
ds_read_b64_tr_b16 v[98:99], v4 offset:21504
ds_read_b64_tr_b16 v[100:101], v3 offset:22528
ds_read_b64_tr_b16 v[102:103], v4 offset:22528
s_waitcnt lgkmcnt(0)
s_waitcnt vmcnt(12)
s_mov_b32 s7, 61440
buffer_load_dwordx4 v[140:143], v1, s[12:15], s7 offen nt
s_mov_b32 s7, 65536
buffer_load_dwordx4 v[144:147], v1, s[12:15], s7 offen nt
s_add_u32 s7, s78, 65536
s_add_u32 m0, s82, 33792
s_nop 0
buffer_load_dwordx4 v17, s[32:35], s7 offen nt lds
s_mov_b32 s7, 69632
buffer_load_dwordx4 v[148:151], v1, s[12:15], s7 offen nt
s_add_u32 s7, s74, 20480
v_add_u32 v72, s7, v16
ds_write_b128 v72, v[104:107] offset:0
ds_write_b128 v72, v[108:111] offset:1024
ds_write_b128 v72, v[112:115] offset:2048
s_waitcnt lgkmcnt(0)
ds_read_b64_tr_b16 v[104:105], v3 offset:20480
ds_read_b64_tr_b16 v[106:107], v4 offset:20480
ds_read_b64_tr_b16 v[108:109], v3 offset:21504
ds_read_b64_tr_b16 v[110:111], v4 offset:21504
ds_read_b64_tr_b16 v[112:113], v3 offset:22528
ds_read_b64_tr_b16 v[114:115], v4 offset:22528
s_waitcnt lgkmcnt(0)
s_waitcnt vmcnt(12)
s_mov_b32 s7, 73728
buffer_load_dwordx4 v[152:155], v1, s[12:15], s7 offen nt
s_mov_b32 s7, 77824
buffer_load_dwordx4 v[156:159], v1, s[12:15], s7 offen nt
s_add_u32 s7, s78, 131072
s_add_u32 m0, s82, 34816
s_nop 0
buffer_load_dwordx4 v17, s[32:35], s7 offen nt lds
s_mov_b32 s7, 81920
buffer_load_dwordx4 v[160:163], v1, s[12:15], s7 offen nt
s_add_u32 s7, s74, 20480
v_add_u32 v72, s7, v16
ds_write_b128 v72, v[116:119] offset:0
ds_write_b128 v72, v[120:123] offset:1024
ds_write_b128 v72, v[124:127] offset:2048
s_waitcnt lgkmcnt(0)
ds_read_b64_tr_b16 v[116:117], v3 offset:20480
ds_read_b64_tr_b16 v[118:119], v4 offset:20480
ds_read_b64_tr_b16 v[120:121], v3 offset:21504
ds_read_b64_tr_b16 v[122:123], v4 offset:21504
ds_read_b64_tr_b16 v[124:125], v3 offset:22528
ds_read_b64_tr_b16 v[126:127], v4 offset:22528
s_waitcnt lgkmcnt(0)
s_waitcnt vmcnt(12)
s_mov_b32 s7, 86016
buffer_load_dwordx4 v[164:167], v1, s[12:15], s7 offen nt
s_mov_b32 s7, 90112
s_add_u32 m0, s74, 0
s_nop 0
buffer_load_dwordx4 v16, s[12:15], s7 offen nt lds
s_add_u32 s7, s78, 196608
s_add_u32 m0, s82, 35840
s_nop 0
buffer_load_dwordx4 v17, s[32:35], s7 offen nt lds
s_mov_b32 s7, 94208
s_add_u32 m0, s74, 1024
s_nop 0
buffer_load_dwordx4 v16, s[12:15], s7 offen nt lds
s_waitcnt lgkmcnt(0)
s_mov_b32 s75, 0
CSL_13:
v_max3_u32 v52, v44, v45, v46
v_max3_u32 v53, v47, v48, v49
v_max3_u32 v52, v52, v50, v51
v_max_u32 v52, v52, v53
v_cmp_eq_u32 vcc, -1, v52
s_and_b64 vcc, vcc, exec
s_cbranch_scc0 CSD_14
s_sub_u32 s7, s60, 294912
s_lshl_b32 s76, s58, 11
s_sub_u32 s7, s7, s76
s_add_u32 s7, s7, 32768
buffer_load_dwordx4 v[44:47], v1, s[40:43], s7 offen offset:0 sc1
buffer_load_dwordx4 v[48:51], v1, s[40:43], s7 offen offset:1024 sc1
s_waitcnt vmcnt(0)
s_add_u32 s75, s75, 1
s_cmp_lt_u32 s75, 20000
s_cbranch_scc1 CSL_13
CSD_14:
v_add_f32_dpp v44, v44, v44 quad_perm:[1,0,3,2] row_mask:0xf bank_mask:0xf
v_add_f32_dpp v45, v45, v45 quad_perm:[1,0,3,2] row_mask:0xf bank_mask:0xf
v_add_f32_dpp v46, v46, v46 quad_perm:[1,0,3,2] row_mask:0xf bank_mask:0xf
v_add_f32_dpp v47, v47, v47 quad_perm:[1,0,3,2] row_mask:0xf bank_mask:0xf
v_add_f32_dpp v48, v48, v48 quad_perm:[1,0,3,2] row_mask:0xf bank_mask:0xf
v_add_f32_dpp v49, v49, v49 quad_perm:[1,0,3,2] row_mask:0xf bank_mask:0xf
v_add_f32_dpp v50, v50, v50 quad_perm:[1,0,3,2] row_mask:0xf bank_mask:0xf
v_add_f32_dpp v51, v51, v51 quad_perm:[1,0,3,2] row_mask:0xf bank_mask:0xf
v_add_f32_dpp v44, v44, v44 quad_perm:[2,3,0,1] row_mask:0xf bank_mask:0xf
v_add_f32_dpp v45, v45, v45 quad_perm:[2,3,0,1] row_mask:0xf bank_mask:0xf
v_add_f32_dpp v46, v46, v46 quad_perm:[2,3,0,1] row_mask:0xf bank_mask:0xf
v_add_f32_dpp v47, v47, v47 quad_perm:[2,3,0,1] row_mask:0xf bank_mask:0xf
v_add_f32_dpp v48, v48, v48 quad_perm:[2,3,0,1] row_mask:0xf bank_mask:0xf
v_add_f32_dpp v49, v49, v49 quad_perm:[2,3,0,1] row_mask:0xf bank_mask:0xf
v_add_f32_dpp v50, v50, v50 quad_perm:[2,3,0,1] row_mask:0xf bank_mask:0xf
v_add_f32_dpp v51, v51, v51 quad_perm:[2,3,0,1] row_mask:0xf bank_mask:0xf
s_waitcnt lgkmcnt(0)
s_mov_b64 exec, s[70:71]
ds_write_b128 v21, v[44:47]
ds_write_b128 v21, v[48:51] offset:16
s_mov_b64 exec, -1
v_mov_b32 v34, v44
v_mov_b32 v35, v45
v_mov_b32 v36, v46
v_mov_b32 v37, v47
v_mov_b32 v38, v48
v_mov_b32 v39, v49
v_mov_b32 v40, v50
v_mov_b32 v41, v51
s_waitcnt lgkmcnt(0)
s_nop 7
s_branch C_A
S_PV:
s_nop 7
s_cmp_eq_u32 s4, 0
s_cbranch_scc0 S_PV_1
s_waitcnt lgkmcnt(0)
s_waitcnt vmcnt(12)
s_mov_b32 s7, 98304
s_add_u32 m0, s74, 2048
s_nop 0
buffer_load_dwordx4 v16, s[12:15], s7 offen nt lds
s_mov_b32 s7, 102400
s_add_u32 m0, s74, 3072
s_nop 0
buffer_load_dwordx4 v16, s[12:15], s7 offen nt lds
s_mov_b32 s7, 106496
s_add_u32 m0, s74, 4096
s_nop 0
buffer_load_dwordx4 v16, s[12:15], s7 offen nt lds
s_mov_b32 s7, 110592
s_add_u32 m0, s74, 5120
s_nop 0
buffer_load_dwordx4 v16, s[12:15], s7 offen nt lds
s_add_u32 s7, s74, 20480
v_add_u32 v72, s7, v16
ds_write_b128 v72, v[128:131] offset:0
ds_write_b128 v72, v[132:135] offset:1024
ds_write_b128 v72, v[136:139] offset:2048
s_waitcnt lgkmcnt(0)
ds_read_b64_tr_b16 v[128:129], v3 offset:20480
ds_read_b64_tr_b16 v[130:131], v4 offset:20480
ds_read_b64_tr_b16 v[132:133], v3 offset:21504
ds_read_b64_tr_b16 v[134:135], v4 offset:21504
ds_read_b64_tr_b16 v[136:137], v3 offset:22528
ds_read_b64_tr_b16 v[138:139], v4 offset:22528
s_waitcnt lgkmcnt(0)
s_waitcnt vmcnt(12)
s_mov_b32 s7, 114688
s_add_u32 m0, s74, 6144
s_nop 0
buffer_load_dwordx4 v16, s[12:15], s7 offen nt lds
s_mov_b32 s7, 118784
s_add_u32 m0, s74, 7168
s_nop 0
buffer_load_dwordx4 v16, s[12:15], s7 offen nt lds
s_mov_b32 s7, 122880
s_add_u32 m0, s74, 8192
s_nop 0
buffer_load_dwordx4 v16, s[12:15], s7 offen nt lds
s_mov_b32 s7, 126976
s_add_u32 m0, s74, 9216
s_nop 0
buffer_load_dwordx4 v16, s[12:15], s7 offen nt lds
s_add_u32 s7, s74, 20480
v_add_u32 v72, s7, v16
ds_write_b128 v72, v[140:143] offset:0
ds_write_b128 v72, v[144:147] offset:1024
ds_write_b128 v72, v[148:151] offset:2048
s_waitcnt lgkmcnt(0)
ds_read_b64_tr_b16 v[140:141], v3 offset:20480
ds_read_b64_tr_b16 v[142:143], v4 offset:20480
ds_read_b64_tr_b16 v[144:145], v3 offset:21504
ds_read_b64_tr_b16 v[146:147], v4 offset:21504
ds_read_b64_tr_b16 v[148:149], v3 offset:22528
ds_read_b64_tr_b16 v[150:151], v4 offset:22528
s_waitcnt lgkmcnt(0)
s_waitcnt vmcnt(8)
s_mov_b32 s7, 0
buffer_load_dwordx4 a[128:131], v1, s[16:19], s7 offen nt
s_mov_b32 s7, 4096
buffer_load_dwordx4 a[132:135], v1, s[16:19], s7 offen nt
s_add_u32 s7, s74, 20480
v_add_u32 v72, s7, v16
ds_write_b128 v72, v[152:155] offset:0
ds_write_b128 v72, v[156:159] offset:1024
ds_write_b128 v72, v[160:163] offset:2048
s_waitcnt lgkmcnt(0)
ds_read_b64_tr_b16 v[152:153], v3 offset:20480
ds_read_b64_tr_b16 v[154:155], v4 offset:20480
ds_read_b64_tr_b16 v[156:157], v3 offset:21504
ds_read_b64_tr_b16 v[158:159], v4 offset:21504
ds_read_b64_tr_b16 v[160:161], v3 offset:22528
ds_read_b64_tr_b16 v[162:163], v4 offset:22528
s_waitcnt lgkmcnt(0)
s_add_u32 s7, s74, 20480
v_add_u32 v72, s7, v16
ds_write_b128 v72, v[164:167] offset:0
s_waitcnt lgkmcnt(0)
ds_read_b64_tr_b16 v[164:165], v3 offset:20480
ds_read_b64_tr_b16 v[166:167], v4 offset:20480
s_waitcnt lgkmcnt(0)
s_waitcnt vmcnt(8)
s_mov_b32 s7, 8192
buffer_load_dwordx4 a[136:139], v1, s[16:19], s7 offen nt
s_mov_b32 s7, 12288
buffer_load_dwordx4 a[140:143], v1, s[16:19], s7 offen nt
s_waitcnt vmcnt(8)
s_mov_b32 s7, 16384
buffer_load_dwordx4 a[144:147], v1, s[16:19], s7 offen nt
s_mov_b32 s7, 20480
buffer_load_dwordx4 a[148:151], v1, s[16:19], s7 offen nt
s_waitcnt vmcnt(8)
s_mov_b32 s7, 24576
buffer_load_dwordx4 a[152:155], v1, s[16:19], s7 offen nt
s_mov_b32 s7, 28672
buffer_load_dwordx4 a[156:159], v1, s[16:19], s7 offen nt
s_waitcnt vmcnt(8)
s_mov_b32 s7, 32768
buffer_load_dwordx4 a[160:163], v1, s[16:19], s7 offen nt
s_mov_b32 s7, 36864
buffer_load_dwordx4 a[164:167], v1, s[16:19], s7 offen nt
ds_read_b64_tr_b16 v[44:45], v3 offset:0
ds_read_b64_tr_b16 v[46:47], v4 offset:0
ds_read_b64_tr_b16 v[48:49], v3 offset:1024
ds_read_b64_tr_b16 v[50:51], v4 offset:1024
ds_read_b64_tr_b16 v[52:53], v3 offset:2048
ds_read_b64_tr_b16 v[54:55], v4 offset:2048
ds_read_b64_tr_b16 v[56:57], v3 offset:3072
ds_read_b64_tr_b16 v[58:59], v4 offset:3072
ds_read_b64_tr_b16 v[60:61], v3 offset:4096
ds_read_b64_tr_b16 v[62:63], v4 offset:4096
s_nop 7
s_branch R_PV
S_B:
s_nop 7
s_cmp_eq_u32 s3, 1
s_cbranch_scc1 P_B
s_waitcnt vmcnt(6)
s_mov_b32 s7, 40960
buffer_load_dwordx4 a[168:171], v1, s[16:19], s7 offen nt
s_mov_b32 s7, 45056
buffer_load_dwordx4 a[172:175], v1, s[16:19], s7 offen nt
v_mov_b32 v72, 161828
ds_read_b32 v73, v72
s_waitcnt lgkmcnt(0)
v_readfirstlane_b32 s7, v73
s_cmp_lt_u32 s7, 1
s_cbranch_scc0 SW_16
s_waitcnt vmcnt(6)
s_mov_b32 s7, 49152
s_nop 0
buffer_load_dwordx4 a[176:179], v1, s[16:19], s7 offen nt
s_mov_b32 s7, 53248
buffer_load_dwordx4 a[180:183], v1, s[16:19], s7 offen nt
v_mov_b32 v72, 161828
ds_read_b32 v73, v72
s_waitcnt lgkmcnt(0)
v_readfirstlane_b32 s7, v73
s_cmp_lt_u32 s7, 1
s_cbranch_scc0 SW_17
s_waitcnt vmcnt(6)
s_mov_b32 s7, 57344
s_nop 0
buffer_load_dwordx4 a[184:187], v1, s[16:19], s7 offen nt
s_mov_b32 s7, 61440
buffer_load_dwordx4 a[188:191], v1, s[16:19], s7 offen nt
v_mov_b32 v72, 161828
ds_read_b32 v73, v72
s_waitcnt lgkmcnt(0)
v_readfirstlane_b32 s7, v73
s_cmp_lt_u32 s7, 1
s_cbranch_scc0 SW_18
s_waitcnt vmcnt(6)
s_mov_b32 s7, 65536
s_nop 0
buffer_load_dwordx4 a[192:195], v1, s[16:19], s7 offen nt
s_mov_b32 s7, 69632
buffer_load_dwordx4 a[196:199], v1, s[16:19], s7 offen nt
v_mov_b32 v72, 161828
ds_read_b32 v73, v72
s_waitcnt lgkmcnt(0)
v_readfirstlane_b32 s7, v73
s_cmp_lt_u32 s7, 1
s_cbranch_scc0 SW_19
s_waitcnt vmcnt(6)
s_mov_b32 s7, 73728
s_nop 0
buffer_load_dwordx4 a[200:203], v1, s[16:19], s7 offen nt
s_mov_b32 s7, 77824
buffer_load_dwordx4 a[204:207], v1, s[16:19], s7 offen nt
v_mov_b32 v72, 161828
ds_read_b32 v73, v72
s_waitcnt lgkmcnt(0)
v_readfirstlane_b32 s7, v73
s_cmp_lt_u32 s7, 1
s_cbranch_scc0 SW_20
s_mov_b32 s75, 0
SWL_21:
v_mov_b32 v72, 161828
ds_read_b32 v73, v72
s_waitcnt lgkmcnt(0)
v_readfirstlane_b32 s7, v73
s_cmp_lt_u32 s7, 1
s_cbranch_scc0 SWD_22
s_add_u32 s75, s75, 1
s_cmp_lt_u32 s75, 80000
s_cbranch_scc1 SWL_21
s_branch SWD_22
SW_16:
s_mov_b32 s7, 49152
s_nop 1
buffer_load_dwordx4 a[176:179], v1, s[16:19], s7 offen nt
s_mov_b32 s7, 53248
buffer_load_dwordx4 a[180:183], v1, s[16:19], s7 offen nt
SW_17:
s_mov_b32 s7, 57344
s_nop 1
buffer_load_dwordx4 a[184:187], v1, s[16:19], s7 offen nt
s_mov_b32 s7, 61440
buffer_load_dwordx4 a[188:191], v1, s[16:19], s7 offen nt
SW_18:
s_mov_b32 s7, 65536
s_nop 1
buffer_load_dwordx4 a[192:195], v1, s[16:19], s7 offen nt
s_mov_b32 s7, 69632
buffer_load_dwordx4 a[196:199], v1, s[16:19], s7 offen nt
SW_19:
s_mov_b32 s7, 73728
s_nop 1
buffer_load_dwordx4 a[200:203], v1, s[16:19], s7 offen nt
s_mov_b32 s7, 77824
buffer_load_dwordx4 a[204:207], v1, s[16:19], s7 offen nt
SW_20:
SWD_22:
J_B:
v_add_u32 v46, 159744, v7
v_add_u32 v47, 162880, v8
s_waitcnt lgkmcnt(0)
s_mov_b64 exec, s[100:101]
ds_read_b128 v[24:27], v46 offset:0
ds_read_b128 v[28:31], v46 offset:512
ds_read_b128 v[32:35], v46 offset:1024
ds_read_b128 v[36:39], v46 offset:1536
ds_read_b32 v40, v47
s_mov_b64 exec, -1
s_waitcnt lgkmcnt(0)
s_barrier
ds_read_b64_tr_b16 v[56:57], v2 offset:16384
ds_read_b64_tr_b16 v[58:59], v2 offset:16896
ds_read_b64_tr_b16 v[60:61], v2 offset:20480
ds_read_b64_tr_b16 v[62:63], v2 offset:20992
ds_read_b64_tr_b16 v[64:65], v2 offset:24576
ds_read_b64_tr_b16 v[66:67], v2 offset:25088
ds_read_b64_tr_b16 v[68:69], v2 offset:28672
ds_read_b64_tr_b16 v[70:71], v2 offset:29184
s_add_u32 s7, s5, s81
s_add_u32 s44, s86, s7
s_addc_u32 s45, s87, 0
s_cmp_eq_u32 s4, 3
s_cselect_b32 s48, s54, s44
s_cselect_b32 s49, s55, s45
s_cselect_b64 vcc, -1, 0
s_cselect_b32 s7, s56, 0
s_cmp_eq_u32 s7, 0
s_cselect_b32 s50, 2048, 0
v_bfe_u32 v79, v0, 2, 1
v_lshlrev_b32 v79, 10, v79
v_and_b32 v78, 3, v0
v_lshl_add_u32 v79, v78, 3, v79
s_lshl_b32 s7, s57, 5
v_add_u32 v79, s7, v79
v_cndmask_b32 v79, v9, v79, vcc
s_nop 7
s_branch C_B
P_B:
s_nop 7
s_mov_b32 s75, 0
s_sleep 4
PL_23:
s_sleep 4
buffer_load_dwordx4 v[24:27], v1, s[40:43], s62 offen sc1
buffer_load_dwordx4 v[28:31], v1, s[40:43], s62 offen offset:1024 sc1
buffer_load_dword v32, v8, s[40:43], s65 offen sc1
s_waitcnt vmcnt(0)
v_max3_u32 v46, v24, v25, v26
v_max3_u32 v47, v27, v28, v29
v_max3_u32 v46, v46, v30, v31
v_max3_u32 v46, v46, v47, v32
v_cmp_eq_u32 vcc, -1, v46
s_and_b64 vcc, vcc, exec
s_cbranch_scc0 PD_24
s_add_u32 s75, s75, 1
s_cmp_lt_u32 s75, 20000
s_cbranch_scc1 PL_23
PD_24:
v_add_u32 v46, 159744, v1
v_add_u32 v47, 162880, v8
ds_write_b128 v46, v[24:27]
ds_write_b128 v46, v[28:31] offset:1024
ds_write_b32 v47, v32
s_waitcnt lgkmcnt(0)
v_mov_b32 v72, 161828
v_mov_b32 v73, 1
s_mov_b64 exec, 1
ds_write_b32 v72, v73
s_mov_b64 exec, -1
s_nop 7
s_branch J_B
S_YL:
s_nop 7
s_cmp_eq_u32 s3, 0
s_cbranch_scc1 P_C
s_cmp_eq_u32 s3, 1
s_cbranch_scc1 D_B
J_C:
s_add_u32 s5, s5, 524288
s_add_u32 s60, s60, 524288
s_add_u32 s61, s61, 524288
s_add_u32 s62, s62, 524288
s_add_u32 s63, s63, 524288
s_add_u32 s64, s64, 524288
s_add_u32 s92, s92, 524288
s_add_u32 s65, s65, 524288
s_add_u32 s66, s66, 524288
v_add_u32 v2, s85, v2
s_sub_u32 s85, 0, s85
v_add_u32 v21, s93, v21
s_sub_u32 s93, 0, s93
s_waitcnt vmcnt(6)
s_mov_b32 s7, 81920
buffer_load_dwordx4 a[208:211], v1, s[16:19], s7 offen nt
s_mov_b32 s7, 86016
buffer_load_dwordx4 a[212:215], v1, s[16:19], s7 offen nt
v_lshrrev_b32 v74, 4, v0
v_and_b32 v75, 15, v0
v_xor_b32 v75, v75, v74
v_lshlrev_b32 v75, 4, v75
v_lshl_add_u32 v72, v74, 8, v75
s_add_u32 s7, s74, 10240
v_add_u32 v72, s7, v72
v_and_b32 v74, 31, v0
v_lshrrev_b32 v75, 5, v0
v_lshlrev_b32 v75, 3, v75
v_and_b32 v73, 15, v0
v_xor_b32 v73, v73, v75
v_lshlrev_b32 v73, 4, v73
v_lshl_add_u32 v73, v74, 8, v73
v_add_u32 v73, s7, v73
ds_write_b128 v72, a[128:131] offset:0
v_xor_b32 v74, 64, v72
ds_write_b128 v74, a[132:135] offset:1024
v_xor_b32 v75, 128, v72
ds_write_b128 v75, a[136:139] offset:2048
v_xor_b32 v74, 192, v72
ds_write_b128 v74, a[140:143] offset:3072
ds_write_b128 v72, a[144:147] offset:4096
v_xor_b32 v74, 64, v72
ds_write_b128 v74, a[148:151] offset:5120
v_xor_b32 v75, 128, v72
ds_write_b128 v75, a[152:155] offset:6144
v_xor_b32 v74, 192, v72
ds_write_b128 v74, a[156:159] offset:7168
s_waitcnt lgkmcnt(0)
ds_read_b128 a[128:131], v73
v_xor_b32 v74, 16, v73
ds_read_b128 a[132:135], v74
v_xor_b32 v75, 32, v73
ds_read_b128 a[136:139], v75
v_xor_b32 v74, 48, v73
ds_read_b128 a[140:143], v74
v_xor_b32 v75, 64, v73
ds_read_b128 a[144:147], v75
v_xor_b32 v74, 80, v73
ds_read_b128 a[148:151], v74
v_xor_b32 v75, 96, v73
ds_read_b128 a[152:155], v75
v_xor_b32 v74, 112, v73
ds_read_b128 a[156:159], v74
s_waitcnt lgkmcnt(0)
s_waitcnt vmcnt(6)
s_mov_b32 s7, 90112
buffer_load_dwordx4 a[216:219], v1, s[16:19], s7 offen nt
s_mov_b32 s7, 94208
buffer_load_dwordx4 a[220:223], v1, s[16:19], s7 offen nt
v_lshrrev_b32 v74, 4, v0
v_and_b32 v75, 15, v0
v_xor_b32 v75, v75, v74
v_lshlrev_b32 v75, 4, v75
v_lshl_add_u32 v72, v74, 8, v75
s_add_u32 s7, s74, 10240
v_add_u32 v72, s7, v72
v_and_b32 v74, 31, v0
v_lshrrev_b32 v75, 5, v0
v_lshlrev_b32 v75, 3, v75
v_and_b32 v73, 15, v0
v_xor_b32 v73, v73, v75
v_lshlrev_b32 v73, 4, v73
v_lshl_add_u32 v73, v74, 8, v73
v_add_u32 v73, s7, v73
ds_write_b128 v72, a[160:163] offset:0
v_xor_b32 v74, 64, v72
ds_write_b128 v74, a[164:167] offset:1024
v_xor_b32 v75, 128, v72
ds_write_b128 v75, a[168:171] offset:2048
v_xor_b32 v74, 192, v72
ds_write_b128 v74, a[172:175] offset:3072
ds_write_b128 v72, a[176:179] offset:4096
v_xor_b32 v74, 64, v72
ds_write_b128 v74, a[180:183] offset:5120
v_xor_b32 v75, 128, v72
ds_write_b128 v75, a[184:187] offset:6144
v_xor_b32 v74, 192, v72
ds_write_b128 v74, a[188:191] offset:7168
s_waitcnt lgkmcnt(0)
ds_read_b128 a[160:163], v73
v_xor_b32 v74, 16, v73
ds_read_b128 a[164:167], v74
v_xor_b32 v75, 32, v73
ds_read_b128 a[168:171], v75
v_xor_b32 v74, 48, v73
ds_read_b128 a[172:175], v74
v_xor_b32 v75, 64, v73
ds_read_b128 a[176:179], v75
v_xor_b32 v74, 80, v73
ds_read_b128 a[180:183], v74
v_xor_b32 v75, 96, v73
ds_read_b128 a[184:187], v75
v_xor_b32 v74, 112, v73
ds_read_b128 a[188:191], v74
s_waitcnt lgkmcnt(0)
s_waitcnt vmcnt(6)
s_mov_b32 s7, 98304
buffer_load_dwordx4 a[224:227], v1, s[16:19], s7 offen nt
s_mov_b32 s7, 102400
buffer_load_dwordx4 a[228:231], v1, s[16:19], s7 offen nt
s_waitcnt vmcnt(6)
s_mov_b32 s7, 106496
buffer_load_dwordx4 a[232:235], v1, s[16:19], s7 offen nt
s_mov_b32 s7, 110592
buffer_load_dwordx4 a[236:239], v1, s[16:19], s7 offen nt
s_waitcnt vmcnt(6)
s_mov_b32 s7, 114688
buffer_load_dwordx4 a[240:243], v1, s[16:19], s7 offen nt
s_mov_b32 s7, 118784
buffer_load_dwordx4 a[244:247], v1, s[16:19], s7 offen nt
s_waitcnt vmcnt(6)
s_mov_b32 s7, 122880
buffer_load_dwordx4 a[248:251], v1, s[16:19], s7 offen nt
s_mov_b32 s7, 126976
buffer_load_dwordx4 a[252:255], v1, s[16:19], s7 offen nt
s_waitcnt vmcnt(6)
s_mov_b32 s7, 0
buffer_load_dwordx4 v[168:171], v1, s[20:23], s7 offen nt
s_mov_b32 s7, 4096
buffer_load_dwordx4 v[172:175], v1, s[20:23], s7 offen nt
s_waitcnt vmcnt(6)
s_mov_b32 s7, 8192
buffer_load_dwordx4 v[176:179], v1, s[20:23], s7 offen nt
s_mov_b32 s7, 12288
buffer_load_dwordx4 v[180:183], v1, s[20:23], s7 offen nt
s_waitcnt vmcnt(6)
s_add_u32 s7, s79, 0
s_add_u32 m0, s82, 49152
s_nop 0
buffer_load_dwordx4 v18, s[36:39], s7 offen nt lds
s_mov_b32 s7, 16384
buffer_load_dwordx4 v[184:187], v1, s[20:23], s7 offen nt
ds_read_b64_tr_b16 v[40:41], v2 offset:0
ds_read_b64_tr_b16 v[42:43], v2 offset:512
ds_read_b64_tr_b16 v[44:45], v2 offset:4096
ds_read_b64_tr_b16 v[46:47], v2 offset:4608
ds_read_b64_tr_b16 v[48:49], v2 offset:8192
ds_read_b64_tr_b16 v[50:51], v2 offset:8704
ds_read_b64_tr_b16 v[52:53], v2 offset:12288
ds_read_b64_tr_b16 v[54:55], v2 offset:12800
v_mov_b32 v24, 0x3f803f80
v_mov_b32 v25, 0x3f803f80
v_mov_b32 v26, 0x3f803f80
v_mov_b32 v27, 0x3f803f80
v_mov_b32 v28, 0x3f803f80
v_mov_b32 v29, 0x3f803f80
v_mov_b32 v30, 0x3f803f80
v_mov_b32 v31, 0x3f803f80
v_mov_b32 v32, 0x3f803f80
v_mov_b32 v33, 0x3f803f80
v_mov_b32 v34, 0x3f803f80
v_mov_b32 v35, 0x3f803f80
v_mov_b32 v36, 0x3f803f80
v_mov_b32 v37, 0x3f803f80
v_mov_b32 v38, 0x3f803f80
v_mov_b32 v39, 0x3f803f80
s_add_u32 s67, s67, 524288
s_add_u32 s4, s4, 1
s_cmp_eq_u32 s3, 2
s_cbranch_scc1 P_D
J_DS:
s_waitcnt vmcnt(6)
s_mov_b32 s7, 20480
buffer_load_dwordx4 v[188:191], v1, s[20:23], s7 offen nt
s_mov_b32 s7, 24576
buffer_load_dwordx4 v[192:195], v1, s[20:23], s7 offen nt
v_lshrrev_b32 v74, 4, v0
v_and_b32 v75, 15, v0
v_xor_b32 v75, v75, v74
v_lshlrev_b32 v75, 4, v75
v_lshl_add_u32 v72, v74, 8, v75
s_add_u32 s7, s74, 10240
v_add_u32 v72, s7, v72
v_and_b32 v74, 31, v0
v_lshrrev_b32 v75, 5, v0
v_lshlrev_b32 v75, 3, v75
v_and_b32 v73, 15, v0
v_xor_b32 v73, v73, v75
v_lshlrev_b32 v73, 4, v73
v_lshl_add_u32 v73, v74, 8, v73
v_add_u32 v73, s7, v73
ds_write_b128 v72, a[192:195] offset:0
v_xor_b32 v74, 64, v72
ds_write_b128 v74, a[196:199] offset:1024
v_xor_b32 v75, 128, v72
ds_write_b128 v75, a[200:203] offset:2048
v_xor_b32 v74, 192, v72
ds_write_b128 v74, a[204:207] offset:3072
ds_write_b128 v72, a[208:211] offset:4096
v_xor_b32 v74, 64, v72
ds_write_b128 v74, a[212:215] offset:5120
v_xor_b32 v75, 128, v72
ds_write_b128 v75, a[216:219] offset:6144
v_xor_b32 v74, 192, v72
ds_write_b128 v74, a[220:223] offset:7168
s_waitcnt lgkmcnt(0)
ds_read_b128 a[192:195], v73
v_xor_b32 v74, 16, v73
ds_read_b128 a[196:199], v74
v_xor_b32 v75, 32, v73
ds_read_b128 a[200:203], v75
v_xor_b32 v74, 48, v73
ds_read_b128 a[204:207], v74
v_xor_b32 v75, 64, v73
ds_read_b128 a[208:211], v75
v_xor_b32 v74, 80, v73
ds_read_b128 a[212:215], v74
v_xor_b32 v75, 96, v73
ds_read_b128 a[216:219], v75
v_xor_b32 v74, 112, v73
ds_read_b128 a[220:223], v74
s_waitcnt lgkmcnt(0)
v_lshrrev_b32 v74, 4, v0
v_and_b32 v75, 15, v0
v_xor_b32 v75, v75, v74
v_lshlrev_b32 v75, 4, v75
v_lshl_add_u32 v72, v74, 8, v75
s_add_u32 s7, s74, 10240
v_add_u32 v72, s7, v72
v_and_b32 v74, 31, v0
v_lshrrev_b32 v75, 5, v0
v_lshlrev_b32 v75, 3, v75
v_and_b32 v73, 15, v0
v_xor_b32 v73, v73, v75
v_lshlrev_b32 v73, 4, v73
v_lshl_add_u32 v73, v74, 8, v73
v_add_u32 v73, s7, v73
ds_write_b128 v72, a[224:227] offset:0
v_xor_b32 v74, 64, v72
ds_write_b128 v74, a[228:231] offset:1024
v_xor_b32 v75, 128, v72
ds_write_b128 v75, a[232:235] offset:2048
v_xor_b32 v74, 192, v72
ds_write_b128 v74, a[236:239] offset:3072
ds_write_b128 v72, a[240:243] offset:4096
v_xor_b32 v74, 64, v72
ds_write_b128 v74, a[244:247] offset:5120
v_xor_b32 v75, 128, v72
ds_write_b128 v75, a[248:251] offset:6144
v_xor_b32 v74, 192, v72
ds_write_b128 v74, a[252:255] offset:7168
s_waitcnt lgkmcnt(0)
ds_read_b128 a[224:227], v73
v_xor_b32 v74, 16, v73
ds_read_b128 a[228:231], v74
v_xor_b32 v75, 32, v73
ds_read_b128 a[232:235], v75
v_xor_b32 v74, 48, v73
ds_read_b128 a[236:239], v74
v_xor_b32 v75, 64, v73
ds_read_b128 a[240:243], v75
v_xor_b32 v74, 80, v73
ds_read_b128 a[244:247], v74
v_xor_b32 v75, 96, v73
ds_read_b128 a[248:251], v75
v_xor_b32 v74, 112, v73
ds_read_b128 a[252:255], v74
s_waitcnt lgkmcnt(0)
s_waitcnt vmcnt(6)
s_mov_b32 s7, 28672
buffer_load_dwordx4 v[196:199], v1, s[20:23], s7 offen nt
s_add_u32 s7, s79, 8192
s_add_u32 m0, s82, 50176
s_nop 0
buffer_load_dwordx4 v18, s[36:39], s7 offen nt lds
s_waitcnt vmcnt(6)
s_mov_b32 s7, 32768
buffer_load_dwordx4 v[200:203], v1, s[20:23], s7 offen nt
s_mov_b32 s7, 36864
buffer_load_dwordx4 v[204:207], v1, s[20:23], s7 offen nt
v_mov_b32 v72, 161828
ds_read_b32 v73, v72
s_waitcnt lgkmcnt(0)
v_readfirstlane_b32 s7, v73
s_cmp_lt_u32 s7, 2
s_cbranch_scc0 SW_26
s_waitcnt vmcnt(6)
s_mov_b32 s7, 40960
s_nop 0
buffer_load_dwordx4 v[208:211], v1, s[20:23], s7 offen nt
s_mov_b32 s7, 45056
buffer_load_dwordx4 v[212:215], v1, s[20:23], s7 offen nt
v_mov_b32 v72, 161828
ds_read_b32 v73, v72
s_waitcnt lgkmcnt(0)
v_readfirstlane_b32 s7, v73
s_cmp_lt_u32 s7, 2
s_cbranch_scc0 SW_27
s_waitcnt vmcnt(6)
s_add_u32 s7, s79, 16384
s_add_u32 m0, s82, 51200
s_nop 0
buffer_load_dwordx4 v18, s[36:39], s7 offen nt lds
s_mov_b32 s7, 49152
buffer_load_dwordx4 v[216:219], v1, s[20:23], s7 offen nt
v_mov_b32 v72, 161828
ds_read_b32 v73, v72
s_waitcnt lgkmcnt(0)
v_readfirstlane_b32 s7, v73
s_cmp_lt_u32 s7, 2
s_cbranch_scc0 SW_28
s_waitcnt vmcnt(6)
s_mov_b32 s7, 53248
s_nop 0
buffer_load_dwordx4 v[220:223], v1, s[20:23], s7 offen nt
s_mov_b32 s7, 57344
buffer_load_dwordx4 v[224:227], v1, s[20:23], s7 offen nt
v_mov_b32 v72, 161828
ds_read_b32 v73, v72
s_waitcnt lgkmcnt(0)
v_readfirstlane_b32 s7, v73
s_cmp_lt_u32 s7, 2
s_cbranch_scc0 SW_29
s_waitcnt vmcnt(6)
s_mov_b32 s7, 61440
s_nop 0
buffer_load_dwordx4 v[228:231], v1, s[20:23], s7 offen nt
s_add_u32 s7, s79, 24576
s_add_u32 m0, s82, 52224
s_nop 0
buffer_load_dwordx4 v18, s[36:39], s7 offen nt lds
v_mov_b32 v72, 161828
ds_read_b32 v73, v72
s_waitcnt lgkmcnt(0)
v_readfirstlane_b32 s7, v73
s_cmp_lt_u32 s7, 2
s_cbranch_scc0 SW_30
s_waitcnt vmcnt(6)
s_mov_b32 s7, 65536
s_nop 0
buffer_load_dwordx4 v[232:235], v1, s[20:23], s7 offen nt
s_mov_b32 s7, 69632
buffer_load_dwordx4 v[236:239], v1, s[20:23], s7 offen nt
v_mov_b32 v72, 161828
ds_read_b32 v73, v72
s_waitcnt lgkmcnt(0)
v_readfirstlane_b32 s7, v73
s_cmp_lt_u32 s7, 2
s_cbranch_scc0 SW_31
s_mov_b32 s75, 0
SWL_32:
v_mov_b32 v72, 161828
ds_read_b32 v73, v72
s_waitcnt lgkmcnt(0)
v_readfirstlane_b32 s7, v73
s_cmp_lt_u32 s7, 2
s_cbranch_scc0 SWD_33
s_add_u32 s75, s75, 1
s_cmp_lt_u32 s75, 80000
s_cbranch_scc1 SWL_32
s_branch SWD_33
SW_26:
s_mov_b32 s7, 40960
s_nop 1
buffer_load_dwordx4 v[208:211], v1, s[20:23], s7 offen nt
s_mov_b32 s7, 45056
buffer_load_dwordx4 v[212:215], v1, s[20:23], s7 offen nt
SW_27:
s_add_u32 s7, s79, 16384
s_add_u32 m0, s82, 51200
s_nop 0
buffer_load_dwordx4 v18, s[36:39], s7 offen nt lds
s_mov_b32 s7, 49152
buffer_load_dwordx4 v[216:219], v1, s[20:23], s7 offen nt
SW_28:
s_mov_b32 s7, 53248
s_nop 1
buffer_load_dwordx4 v[220:223], v1, s[20:23], s7 offen nt
s_mov_b32 s7, 57344
buffer_load_dwordx4 v[224:227], v1, s[20:23], s7 offen nt
SW_29:
s_mov_b32 s7, 61440
s_nop 1
buffer_load_dwordx4 v[228:231], v1, s[20:23], s7 offen nt
s_add_u32 s7, s79, 24576
s_add_u32 m0, s82, 52224
s_nop 0
buffer_load_dwordx4 v18, s[36:39], s7 offen nt lds
SW_30:
s_mov_b32 s7, 65536
s_nop 1
buffer_load_dwordx4 v[232:235], v1, s[20:23], s7 offen nt
s_mov_b32 s7, 69632
buffer_load_dwordx4 v[236:239], v1, s[20:23], s7 offen nt
SW_31:
SWD_33:
J_D:
s_and_b32 s7, s59, 3
s_lshl_b32 s7, s7, 9
s_sub_u32 s7, 159744, s7
v_add_u32 v68, s7, v5
s_waitcnt lgkmcnt(0)
s_mov_b64 exec, s[68:69]
ds_read_b128 v[24:27], v68 offset:0
ds_read_b128 v[28:31], v68 offset:128
ds_read_b128 v[32:35], v68 offset:256
ds_read_b128 v[36:39], v68 offset:384
s_mov_b64 exec, -1
s_waitcnt lgkmcnt(0)
s_barrier
s_nop 7
s_branch C_D
D_B:
s_nop 7
s_mov_b32 s7, 40960
buffer_load_dwordx4 a[168:171], v1, s[16:19], s7 offen nt
s_mov_b32 s7, 45056
buffer_load_dwordx4 a[172:175], v1, s[16:19], s7 offen nt
s_mov_b32 s7, 49152
buffer_load_dwordx4 a[176:179], v1, s[16:19], s7 offen nt
s_mov_b32 s7, 53248
buffer_load_dwordx4 a[180:183], v1, s[16:19], s7 offen nt
s_mov_b32 s7, 57344
buffer_load_dwordx4 a[184:187], v1, s[16:19], s7 offen nt
s_mov_b32 s7, 61440
buffer_load_dwordx4 a[188:191], v1, s[16:19], s7 offen nt
s_mov_b32 s7, 65536
buffer_load_dwordx4 a[192:195], v1, s[16:19], s7 offen nt
s_mov_b32 s7, 69632
buffer_load_dwordx4 a[196:199], v1, s[16:19], s7 offen nt
s_mov_b32 s7, 73728
buffer_load_dwordx4 a[200:203], v1, s[16:19], s7 offen nt
s_mov_b32 s7, 77824
buffer_load_dwordx4 a[204:207], v1, s[16:19], s7 offen nt
s_waitcnt vmcnt(16)
s_nop 7
s_branch J_C
P_C:
s_nop 7
s_add_u32 s5, s5, 524288
s_add_u32 s60, s60, 524288
s_add_u32 s61, s61, 524288
s_add_u32 s62, s62, 524288
s_add_u32 s63, s63, 524288
s_add_u32 s64, s64, 524288
s_add_u32 s92, s92, 524288
s_add_u32 s65, s65, 524288
s_add_u32 s66, s66, 524288
v_add_u32 v2, s85, v2
s_sub_u32 s85, 0, s85
v_add_u32 v21, s93, v21
s_sub_u32 s93, 0, s93
s_waitcnt lgkmcnt(0)
s_mov_b32 s75, 0
s_sleep 16
PL_34:
s_sleep 8
buffer_load_dwordx4 v[56:59], v1, s[40:43], s67 offen offset:0 sc1
buffer_load_dwordx4 v[60:63], v1, s[40:43], s67 offen offset:1024 sc1
buffer_load_dwordx4 v[64:67], v1, s[40:43], s67 offen offset:2048 sc1
buffer_load_dwordx4 v[68:71], v1, s[40:43], s67 offen offset:3072 sc1
s_waitcnt vmcnt(0)
v_max3_u32 v72, v56, v57, v58
v_max3_u32 v73, v59, v60, v61
v_max3_u32 v72, v72, v62, v63
v_max3_u32 v73, v73, v64, v65
v_max3_u32 v72, v72, v66, v67
v_max3_u32 v73, v73, v68, v69
v_max3_u32 v72, v72, v70, v71
v_max_u32 v72, v72, v73
v_cmp_eq_u32 vcc, -1, v72
s_and_b64 vcc, vcc, exec
s_cbranch_scc0 PD_35
s_add_u32 s75, s75, 1
s_cmp_lt_u32 s75, 20000
s_cbranch_scc1 PL_34
PD_35:
s_nop 7
s_branch K_C
S_X1:
s_nop 7
s_add_u32 s67, s67, 524288
s_add_u32 s4, s4, 1
ds_read_b64_tr_b16 v[40:41], v2 offset:0
ds_read_b64_tr_b16 v[42:43], v2 offset:512
ds_read_b64_tr_b16 v[44:45], v2 offset:4096
ds_read_b64_tr_b16 v[46:47], v2 offset:4608
ds_read_b64_tr_b16 v[48:49], v2 offset:8192
ds_read_b64_tr_b16 v[50:51], v2 offset:8704
ds_read_b64_tr_b16 v[52:53], v2 offset:12288
ds_read_b64_tr_b16 v[54:55], v2 offset:12800
v_mov_b32 v24, 0x3f803f80
v_mov_b32 v25, 0x3f803f80
v_mov_b32 v26, 0x3f803f80
v_mov_b32 v27, 0x3f803f80
v_mov_b32 v28, 0x3f803f80
v_mov_b32 v29, 0x3f803f80
v_mov_b32 v30, 0x3f803f80
v_mov_b32 v31, 0x3f803f80
v_mov_b32 v32, 0x3f803f80
v_mov_b32 v33, 0x3f803f80
v_mov_b32 v34, 0x3f803f80
v_mov_b32 v35, 0x3f803f80
v_mov_b32 v36, 0x3f803f80
v_mov_b32 v37, 0x3f803f80
v_mov_b32 v38, 0x3f803f80
v_mov_b32 v39, 0x3f803f80
s_mov_b32 s7, 81920
buffer_load_dwordx4 a[208:211], v1, s[16:19], s7 offen nt
s_mov_b32 s7, 86016
buffer_load_dwordx4 a[212:215], v1, s[16:19], s7 offen nt
s_mov_b32 s7, 90112
buffer_load_dwordx4 a[216:219], v1, s[16:19], s7 offen nt
s_mov_b32 s7, 94208
buffer_load_dwordx4 a[220:223], v1, s[16:19], s7 offen nt
s_mov_b32 s7, 98304
buffer_load_dwordx4 a[224:227], v1, s[16:19], s7 offen nt
s_mov_b32 s7, 102400
buffer_load_dwordx4 a[228:231], v1, s[16:19], s7 offen nt
s_mov_b32 s7, 106496
buffer_load_dwordx4 a[232:235], v1, s[16:19], s7 offen nt
s_mov_b32 s7, 110592
buffer_load_dwordx4 a[236:239], v1, s[16:19], s7 offen nt
s_mov_b32 s7, 114688
buffer_load_dwordx4 a[240:243], v1, s[16:19], s7 offen nt
s_mov_b32 s7, 118784
buffer_load_dwordx4 a[244:247], v1, s[16:19], s7 offen nt
s_mov_b32 s7, 122880
buffer_load_dwordx4 a[248:251], v1, s[16:19], s7 offen nt
s_mov_b32 s7, 126976
buffer_load_dwordx4 a[252:255], v1, s[16:19], s7 offen nt
s_mov_b32 s7, 0
buffer_load_dwordx4 v[168:171], v1, s[20:23], s7 offen nt
s_mov_b32 s7, 4096
buffer_load_dwordx4 v[172:175], v1, s[20:23], s7 offen nt
s_mov_b32 s7, 8192
buffer_load_dwordx4 v[176:179], v1, s[20:23], s7 offen nt
s_mov_b32 s7, 12288
buffer_load_dwordx4 v[180:183], v1, s[20:23], s7 offen nt
s_add_u32 s7, s79, 0
s_add_u32 m0, s82, 49152
s_nop 0
buffer_load_dwordx4 v18, s[36:39], s7 offen nt lds
s_mov_b32 s7, 16384
buffer_load_dwordx4 v[184:187], v1, s[20:23], s7 offen nt
s_mov_b32 s75, 0
W0L_36:
v_mov_b32 v72, 161828
ds_read_b32 v73, v72
s_waitcnt lgkmcnt(0)
v_readfirstlane_b32 s7, v73
s_cmp_lt_u32 s7, 2
s_cbranch_scc0 W0D_37
s_add_u32 s75, s75, 1
s_cmp_lt_u32 s75, 160000
s_cbranch_scc1 W0L_36
W0D_37:
s_nop 7
s_branch J_D
P_D:
s_nop 7
s_mov_b32 s76, -1
s_mov_b32 s77, 0
s_mov_b32 s75, 0
PL_38:
s_sleep 8
s_and_b32 s7, s59, 3
s_lshl_b32 s7, s7, 9
s_mov_b32 exec_hi, 0
buffer_load_dwordx4 v[64:67], v1, s[44:47], s7 offen sc1
s_mov_b64 exec, -1
s_waitcnt vmcnt(0)
v_max3_u32 v69, v64, v65, v66
v_max_u32 v69, v69, v67
v_cmp_eq_u32 vcc, -1, v69
s_and_b64 vcc, vcc, s[76:77]
s_cbranch_scc0 PD_39
s_add_u32 s75, s75, 1
s_cmp_lt_u32 s75, 20000
s_cbranch_scc1 PL_38
PD_39:
v_add_u32 v68, 159744, v1
ds_write_b128 v68, v[64:67]
s_waitcnt lgkmcnt(0)
v_mov_b32 v72, 161828
v_mov_b32 v73, 2
s_mov_b64 exec, 1
ds_write_b32 v72, v73
s_mov_b64 exec, -1
s_nop 7
s_branch J_D
S_A0_1:
s_nop 7
v_and_b32 v72, 0x7ff, v10
s_sub_u32 s7, s60, 294912
s_lshr_b32 s76, s58, 0
s_lshl_b32 s76, s58, 11
s_sub_u32 s7, s7, s76
s_add_u32 s7, s7, 32768
s_mov_b32 exec_lo, 0x00040004
s_mov_b32 exec_hi, 0x00040004
buffer_store_dwordx4 v[56:59], v72, s[40:43], s7 offen sc1
s_mov_b64 exec, -1
s_cmp_eq_u32 s3, 3
s_cbranch_scc1 P_A
s_cmp_eq_u32 s3, 2
s_cbranch_scc1 D_D
s_cmp_eq_u32 s3, 0
s_cbranch_scc1 D_0
J_A:
s_waitcnt vmcnt(6)
s_mov_b32 s7, 73728
buffer_load_dwordx4 v[240:243], v1, s[20:23], s7 offen nt
s_mov_b32 s7, 77824
buffer_load_dwordx4 v[244:247], v1, s[20:23], s7 offen nt
s_add_u32 s7, s74, 20480
v_add_u32 v72, s7, v16
ds_write_b128 v72, v[168:171] offset:0
ds_write_b128 v72, v[172:175] offset:1024
ds_write_b128 v72, v[176:179] offset:2048
s_waitcnt lgkmcnt(0)
ds_read_b64_tr_b16 v[168:169], v3 offset:20480
ds_read_b64_tr_b16 v[170:171], v4 offset:20480
ds_read_b64_tr_b16 v[172:173], v3 offset:21504
ds_read_b64_tr_b16 v[174:175], v4 offset:21504
ds_read_b64_tr_b16 v[176:177], v3 offset:22528
ds_read_b64_tr_b16 v[178:179], v4 offset:22528
s_waitcnt lgkmcnt(0)
s_add_u32 s7, s74, 20480
v_add_u32 v72, s7, v16
ds_write_b128 v72, v[180:183] offset:0
ds_write_b128 v72, v[184:187] offset:1024
ds_write_b128 v72, v[188:191] offset:2048
s_waitcnt lgkmcnt(0)
ds_read_b64_tr_b16 v[180:181], v3 offset:20480
ds_read_b64_tr_b16 v[182:183], v4 offset:20480
ds_read_b64_tr_b16 v[184:185], v3 offset:21504
ds_read_b64_tr_b16 v[186:187], v4 offset:21504
ds_read_b64_tr_b16 v[188:189], v3 offset:22528
ds_read_b64_tr_b16 v[190:191], v4 offset:22528
s_waitcnt lgkmcnt(0)
s_add_u32 s7, s74, 20480
v_add_u32 v72, s7, v16
ds_write_b128 v72, v[192:195] offset:0
ds_write_b128 v72, v[196:199] offset:1024
ds_write_b128 v72, v[200:203] offset:2048
s_waitcnt lgkmcnt(0)
ds_read_b64_tr_b16 v[192:193], v3 offset:20480
ds_read_b64_tr_b16 v[194:195], v4 offset:20480
ds_read_b64_tr_b16 v[196:197], v3 offset:21504
ds_read_b64_tr_b16 v[198:199], v4 offset:21504
ds_read_b64_tr_b16 v[200:201], v3 offset:22528
ds_read_b64_tr_b16 v[202:203], v4 offset:22528
s_waitcnt lgkmcnt(0)
s_add_u32 s7, s74, 20480
v_add_u32 v72, s7, v16
ds_write_b128 v72, v[204:207] offset:0
ds_write_b128 v72, v[208:211] offset:1024
ds_write_b128 v72, v[212:215] offset:2048
s_waitcnt lgkmcnt(0)
ds_read_b64_tr_b16 v[204:205], v3 offset:20480
ds_read_b64_tr_b16 v[206:207], v4 offset:20480
ds_read_b64_tr_b16 v[208:209], v3 offset:21504
ds_read_b64_tr_b16 v[210:211], v4 offset:21504
ds_read_b64_tr_b16 v[212:213], v3 offset:22528
ds_read_b64_tr_b16 v[214:215], v4 offset:22528
s_waitcnt lgkmcnt(0)
s_waitcnt vmcnt(6)
s_mov_b32 s7, 81920
buffer_load_dwordx4 v[248:251], v1, s[20:23], s7 offen nt
s_mov_b32 s7, 86016
buffer_load_dwordx4 v[252:255], v1, s[20:23], s7 offen nt
v_mov_b32 v72, 161828
ds_read_b32 v73, v72
s_waitcnt lgkmcnt(0)
v_readfirstlane_b32 s7, v73
s_cmp_lt_u32 s7, 3
s_cbranch_scc0 SW_41
s_waitcnt vmcnt(6)
s_mov_b32 s7, 90112
s_add_u32 m0, s74, 10240
s_nop 0
buffer_load_dwordx4 v16, s[20:23], s7 offen nt lds
s_mov_b32 s7, 94208
s_add_u32 m0, s74, 11264
s_nop 0
buffer_load_dwordx4 v16, s[20:23], s7 offen nt lds
v_mov_b32 v72, 161828
ds_read_b32 v73, v72
s_waitcnt lgkmcnt(0)
v_readfirstlane_b32 s7, v73
s_cmp_lt_u32 s7, 3
s_cbranch_scc0 SW_42
s_waitcnt vmcnt(6)
s_mov_b32 s7, 98304
s_add_u32 m0, s74, 12288
s_nop 0
buffer_load_dwordx4 v16, s[20:23], s7 offen nt lds
s_mov_b32 s7, 102400
s_add_u32 m0, s74, 13312
s_nop 0
buffer_load_dwordx4 v16, s[20:23], s7 offen nt lds
v_mov_b32 v72, 161828
ds_read_b32 v73, v72
s_waitcnt lgkmcnt(0)
v_readfirstlane_b32 s7, v73
s_cmp_lt_u32 s7, 3
s_cbranch_scc0 SW_43
s_waitcnt vmcnt(6)
s_mov_b32 s7, 106496
s_add_u32 m0, s74, 14336
s_nop 0
buffer_load_dwordx4 v16, s[20:23], s7 offen nt lds
s_mov_b32 s7, 110592
s_add_u32 m0, s74, 15360
s_nop 0
buffer_load_dwordx4 v16, s[20:23], s7 offen nt lds
v_mov_b32 v72, 161828
ds_read_b32 v73, v72
s_waitcnt lgkmcnt(0)
v_readfirstlane_b32 s7, v73
s_cmp_lt_u32 s7, 3
s_cbranch_scc0 SW_44
s_waitcnt vmcnt(6)
s_mov_b32 s7, 114688
s_add_u32 m0, s74, 16384
s_nop 0
buffer_load_dwordx4 v16, s[20:23], s7 offen nt lds
s_mov_b32 s7, 118784
s_add_u32 m0, s74, 17408
s_nop 0
buffer_load_dwordx4 v16, s[20:23], s7 offen nt lds
v_mov_b32 v72, 161828
ds_read_b32 v73, v72
s_waitcnt lgkmcnt(0)
v_readfirstlane_b32 s7, v73
s_cmp_lt_u32 s7, 3
s_cbranch_scc0 SW_45
s_waitcnt vmcnt(6)
s_mov_b32 s7, 122880
s_add_u32 m0, s74, 18432
s_nop 0
buffer_load_dwordx4 v16, s[20:23], s7 offen nt lds
s_mov_b32 s7, 126976
s_add_u32 m0, s74, 19456
s_nop 0
buffer_load_dwordx4 v16, s[20:23], s7 offen nt lds
v_mov_b32 v72, 161828
ds_read_b32 v73, v72
s_waitcnt lgkmcnt(0)
v_readfirstlane_b32 s7, v73
s_cmp_lt_u32 s7, 3
s_cbranch_scc0 SW_46
s_waitcnt vmcnt(6)
v_mov_b32 v72, 161828
ds_read_b32 v73, v72
s_waitcnt lgkmcnt(0)
v_readfirstlane_b32 s7, v73
s_cmp_lt_u32 s7, 3
s_cbranch_scc0 SW_47
s_mov_b32 s75, 0
SWL_48:
v_mov_b32 v72, 161828
ds_read_b32 v73, v72
s_waitcnt lgkmcnt(0)
v_readfirstlane_b32 s7, v73
s_cmp_lt_u32 s7, 3
s_cbranch_scc0 SWD_49
s_add_u32 s75, s75, 1
s_cmp_lt_u32 s75, 80000
s_cbranch_scc1 SWL_48
s_branch SWD_49
SW_41:
s_mov_b32 s7, 90112
s_add_u32 m0, s74, 10240
s_nop 0
buffer_load_dwordx4 v16, s[20:23], s7 offen nt lds
s_mov_b32 s7, 94208
s_add_u32 m0, s74, 11264
s_nop 0
buffer_load_dwordx4 v16, s[20:23], s7 offen nt lds
SW_42:
s_mov_b32 s7, 98304
s_add_u32 m0, s74, 12288
s_nop 0
buffer_load_dwordx4 v16, s[20:23], s7 offen nt lds
s_mov_b32 s7, 102400
s_add_u32 m0, s74, 13312
s_nop 0
buffer_load_dwordx4 v16, s[20:23], s7 offen nt lds
SW_43:
s_mov_b32 s7, 106496
s_add_u32 m0, s74, 14336
s_nop 0
buffer_load_dwordx4 v16, s[20:23], s7 offen nt lds
s_mov_b32 s7, 110592
s_add_u32 m0, s74, 15360
s_nop 0
buffer_load_dwordx4 v16, s[20:23], s7 offen nt lds
SW_44:
s_mov_b32 s7, 114688
s_add_u32 m0, s74, 16384
s_nop 0
buffer_load_dwordx4 v16, s[20:23], s7 offen nt lds
s_mov_b32 s7, 118784
s_add_u32 m0, s74, 17408
s_nop 0
buffer_load_dwordx4 v16, s[20:23], s7 offen nt lds
SW_45:
s_mov_b32 s7, 122880
s_add_u32 m0, s74, 18432
s_nop 0
buffer_load_dwordx4 v16, s[20:23], s7 offen nt lds
s_mov_b32 s7, 126976
s_add_u32 m0, s74, 19456
s_nop 0
buffer_load_dwordx4 v16, s[20:23], s7 offen nt lds
SW_46:
SW_47:
SWD_49:
v_lshrrev_b32 v68, 2, v0
v_lshlrev_b32 v68, 4, v68
v_add_u32 v68, 162944, v68
ds_read_b128 v[76:79], v68
s_waitcnt lgkmcnt(0)
J_F:
s_nop 7
s_branch L_QK
D_D:
s_nop 7
s_mov_b32 s7, 20480
buffer_load_dwordx4 v[188:191], v1, s[20:23], s7 offen nt
s_mov_b32 s7, 24576
buffer_load_dwordx4 v[192:195], v1, s[20:23], s7 offen nt
s_mov_b32 s7, 28672
buffer_load_dwordx4 v[196:199], v1, s[20:23], s7 offen nt
s_add_u32 s7, s79, 8192
s_add_u32 m0, s82, 50176
s_nop 0
buffer_load_dwordx4 v18, s[36:39], s7 offen nt lds
s_mov_b32 s7, 32768
buffer_load_dwordx4 v[200:203], v1, s[20:23], s7 offen nt
s_mov_b32 s7, 36864
buffer_load_dwordx4 v[204:207], v1, s[20:23], s7 offen nt
s_mov_b32 s7, 40960
buffer_load_dwordx4 v[208:211], v1, s[20:23], s7 offen nt
s_mov_b32 s7, 45056
buffer_load_dwordx4 v[212:215], v1, s[20:23], s7 offen nt
s_add_u32 s7, s79, 16384
s_add_u32 m0, s82, 51200
s_nop 0
buffer_load_dwordx4 v18, s[36:39], s7 offen nt lds
s_mov_b32 s7, 49152
buffer_load_dwordx4 v[216:219], v1, s[20:23], s7 offen nt
s_mov_b32 s7, 53248
buffer_load_dwordx4 v[220:223], v1, s[20:23], s7 offen nt
s_mov_b32 s7, 57344
buffer_load_dwordx4 v[224:227], v1, s[20:23], s7 offen nt
s_mov_b32 s7, 61440
buffer_load_dwordx4 v[228:231], v1, s[20:23], s7 offen nt
s_add_u32 s7, s79, 24576
s_add_u32 m0, s82, 52224
s_nop 0
buffer_load_dwordx4 v18, s[36:39], s7 offen nt lds
s_mov_b32 s7, 65536
buffer_load_dwordx4 v[232:235], v1, s[20:23], s7 offen nt
s_mov_b32 s7, 69632
buffer_load_dwordx4 v[236:239], v1, s[20:23], s7 offen nt
v_lshrrev_b32 v74, 4, v0
v_and_b32 v75, 15, v0
v_xor_b32 v75, v75, v74
v_lshlrev_b32 v75, 4, v75
v_lshl_add_u32 v72, v74, 8, v75
s_add_u32 s7, s74, 10240
v_add_u32 v72, s7, v72
v_and_b32 v74, 31, v0
v_lshrrev_b32 v75, 5, v0
v_lshlrev_b32 v75, 3, v75
v_and_b32 v73, 15, v0
v_xor_b32 v73, v73, v75
v_lshlrev_b32 v73, 4, v73
v_lshl_add_u32 v73, v74, 8, v73
v_add_u32 v73, s7, v73
ds_write_b128 v72, a[192:195] offset:0
v_xor_b32 v74, 64, v72
ds_write_b128 v74, a[196:199] offset:1024
v_xor_b32 v75, 128, v72
ds_write_b128 v75, a[200:203] offset:2048
v_xor_b32 v74, 192, v72
ds_write_b128 v74, a[204:207] offset:3072
ds_write_b128 v72, a[208:211] offset:4096
v_xor_b32 v74, 64, v72
ds_write_b128 v74, a[212:215] offset:5120
v_xor_b32 v75, 128, v72
ds_write_b128 v75, a[216:219] offset:6144
v_xor_b32 v74, 192, v72
ds_write_b128 v74, a[220:223] offset:7168
s_waitcnt lgkmcnt(0)
ds_read_b128 a[192:195], v73
v_xor_b32 v74, 16, v73
ds_read_b128 a[196:199], v74
v_xor_b32 v75, 32, v73
ds_read_b128 a[200:203], v75
v_xor_b32 v74, 48, v73
ds_read_b128 a[204:207], v74
v_xor_b32 v75, 64, v73
ds_read_b128 a[208:211], v75
v_xor_b32 v74, 80, v73
ds_read_b128 a[212:215], v74
v_xor_b32 v75, 96, v73
ds_read_b128 a[216:219], v75
v_xor_b32 v74, 112, v73
ds_read_b128 a[220:223], v74
s_waitcnt lgkmcnt(0)
v_lshrrev_b32 v74, 4, v0
v_and_b32 v75, 15, v0
v_xor_b32 v75, v75, v74
v_lshlrev_b32 v75, 4, v75
v_lshl_add_u32 v72, v74, 8, v75
s_add_u32 s7, s74, 10240
v_add_u32 v72, s7, v72
v_and_b32 v74, 31, v0
v_lshrrev_b32 v75, 5, v0
v_lshlrev_b32 v75, 3, v75
v_and_b32 v73, 15, v0
v_xor_b32 v73, v73, v75
v_lshlrev_b32 v73, 4, v73
v_lshl_add_u32 v73, v74, 8, v73
v_add_u32 v73, s7, v73
ds_write_b128 v72, a[224:227] offset:0
v_xor_b32 v74, 64, v72
ds_write_b128 v74, a[228:231] offset:1024
v_xor_b32 v75, 128, v72
ds_write_b128 v75, a[232:235] offset:2048
v_xor_b32 v74, 192, v72
ds_write_b128 v74, a[236:239] offset:3072
ds_write_b128 v72, a[240:243] offset:4096
v_xor_b32 v74, 64, v72
ds_write_b128 v74, a[244:247] offset:5120
v_xor_b32 v75, 128, v72
ds_write_b128 v75, a[248:251] offset:6144
v_xor_b32 v74, 192, v72
ds_write_b128 v74, a[252:255] offset:7168
s_waitcnt lgkmcnt(0)
ds_read_b128 a[224:227], v73
v_xor_b32 v74, 16, v73
ds_read_b128 a[228:231], v74
v_xor_b32 v75, 32, v73
ds_read_b128 a[232:235], v75
v_xor_b32 v74, 48, v73
ds_read_b128 a[236:239], v74
v_xor_b32 v75, 64, v73
ds_read_b128 a[240:243], v75
v_xor_b32 v74, 80, v73
ds_read_b128 a[244:247], v74
v_xor_b32 v75, 96, v73
ds_read_b128 a[248:251], v75
v_xor_b32 v74, 112, v73
ds_read_b128 a[252:255], v74
s_waitcnt lgkmcnt(0)
s_waitcnt vmcnt(18)
s_nop 7
s_branch J_A
D_0:
s_nop 7
s_mov_b32 s7, 20480
buffer_load_dwordx4 v[188:191], v1, s[20:23], s7 offen nt
s_mov_b32 s7, 24576
buffer_load_dwordx4 v[192:195], v1, s[20:23], s7 offen nt
s_mov_b32 s7, 28672
buffer_load_dwordx4 v[196:199], v1, s[20:23], s7 offen nt
s_add_u32 s7, s79, 8192
s_add_u32 m0, s82, 50176
s_nop 0
buffer_load_dwordx4 v18, s[36:39], s7 offen nt lds
s_mov_b32 s7, 32768
buffer_load_dwordx4 v[200:203], v1, s[20:23], s7 offen nt
s_mov_b32 s7, 36864
buffer_load_dwordx4 v[204:207], v1, s[20:23], s7 offen nt
s_mov_b32 s7, 40960
buffer_load_dwordx4 v[208:211], v1, s[20:23], s7 offen nt
s_mov_b32 s7, 45056
buffer_load_dwordx4 v[212:215], v1, s[20:23], s7 offen nt
s_add_u32 s7, s79, 16384
s_add_u32 m0, s82, 51200
s_nop 0
buffer_load_dwordx4 v18, s[36:39], s7 offen nt lds
s_mov_b32 s7, 49152
buffer_load_dwordx4 v[216:219], v1, s[20:23], s7 offen nt
s_mov_b32 s7, 53248
buffer_load_dwordx4 v[220:223], v1, s[20:23], s7 offen nt
s_mov_b32 s7, 57344
buffer_load_dwordx4 v[224:227], v1, s[20:23], s7 offen nt
s_mov_b32 s7, 61440
buffer_load_dwordx4 v[228:231], v1, s[20:23], s7 offen nt
s_add_u32 s7, s79, 24576
s_add_u32 m0, s82, 52224
s_nop 0
buffer_load_dwordx4 v18, s[36:39], s7 offen nt lds
s_mov_b32 s7, 65536
buffer_load_dwordx4 v[232:235], v1, s[20:23], s7 offen nt
s_mov_b32 s7, 69632
buffer_load_dwordx4 v[236:239], v1, s[20:23], s7 offen nt
s_waitcnt vmcnt(16)
v_lshrrev_b32 v74, 4, v0
v_and_b32 v75, 15, v0
v_xor_b32 v75, v75, v74
v_lshlrev_b32 v75, 4, v75
v_lshl_add_u32 v72, v74, 8, v75
s_add_u32 s7, s74, 10240
v_add_u32 v72, s7, v72
v_and_b32 v74, 31, v0
v_lshrrev_b32 v75, 5, v0
v_lshlrev_b32 v75, 3, v75
v_and_b32 v73, 15, v0
v_xor_b32 v73, v73, v75
v_lshlrev_b32 v73, 4, v73
v_lshl_add_u32 v73, v74, 8, v73
v_add_u32 v73, s7, v73
ds_write_b128 v72, a[128:131] offset:0
v_xor_b32 v74, 64, v72
ds_write_b128 v74, a[132:135] offset:1024
v_xor_b32 v75, 128, v72
ds_write_b128 v75, a[136:139] offset:2048
v_xor_b32 v74, 192, v72
ds_write_b128 v74, a[140:143] offset:3072
ds_write_b128 v72, a[144:147] offset:4096
v_xor_b32 v74, 64, v72
ds_write_b128 v74, a[148:151] offset:5120
v_xor_b32 v75, 128, v72
ds_write_b128 v75, a[152:155] offset:6144
v_xor_b32 v74, 192, v72
ds_write_b128 v74, a[156:159] offset:7168
s_waitcnt lgkmcnt(0)
ds_read_b128 a[128:131], v73
v_xor_b32 v74, 16, v73
ds_read_b128 a[132:135], v74
v_xor_b32 v75, 32, v73
ds_read_b128 a[136:139], v75
v_xor_b32 v74, 48, v73
ds_read_b128 a[140:143], v74
v_xor_b32 v75, 64, v73
ds_read_b128 a[144:147], v75
v_xor_b32 v74, 80, v73
ds_read_b128 a[148:151], v74
v_xor_b32 v75, 96, v73
ds_read_b128 a[152:155], v75
v_xor_b32 v74, 112, v73
ds_read_b128 a[156:159], v74
s_waitcnt lgkmcnt(0)
v_lshrrev_b32 v74, 4, v0
v_and_b32 v75, 15, v0
v_xor_b32 v75, v75, v74
v_lshlrev_b32 v75, 4, v75
v_lshl_add_u32 v72, v74, 8, v75
s_add_u32 s7, s74, 10240
v_add_u32 v72, s7, v72
v_and_b32 v74, 31, v0
v_lshrrev_b32 v75, 5, v0
v_lshlrev_b32 v75, 3, v75
v_and_b32 v73, 15, v0
v_xor_b32 v73, v73, v75
v_lshlrev_b32 v73, 4, v73
v_lshl_add_u32 v73, v74, 8, v73
v_add_u32 v73, s7, v73
ds_write_b128 v72, a[160:163] offset:0
v_xor_b32 v74, 64, v72
ds_write_b128 v74, a[164:167] offset:1024
v_xor_b32 v75, 128, v72
ds_write_b128 v75, a[168:171] offset:2048
v_xor_b32 v74, 192, v72
ds_write_b128 v74, a[172:175] offset:3072
ds_write_b128 v72, a[176:179] offset:4096
v_xor_b32 v74, 64, v72
ds_write_b128 v74, a[180:183] offset:5120
v_xor_b32 v75, 128, v72
ds_write_b128 v75, a[184:187] offset:6144
v_xor_b32 v74, 192, v72
ds_write_b128 v74, a[188:191] offset:7168
s_waitcnt lgkmcnt(0)
ds_read_b128 a[160:163], v73
v_xor_b32 v74, 16, v73
ds_read_b128 a[164:167], v74
v_xor_b32 v75, 32, v73
ds_read_b128 a[168:171], v75
v_xor_b32 v74, 48, v73
ds_read_b128 a[172:175], v74
v_xor_b32 v75, 64, v73
ds_read_b128 a[176:179], v75
v_xor_b32 v74, 80, v73
ds_read_b128 a[180:183], v74
v_xor_b32 v75, 96, v73
ds_read_b128 a[184:187], v75
v_xor_b32 v74, 112, v73
ds_read_b128 a[188:191], v74
s_waitcnt lgkmcnt(0)
v_lshrrev_b32 v74, 4, v0
v_and_b32 v75, 15, v0
v_xor_b32 v75, v75, v74
v_lshlrev_b32 v75, 4, v75
v_lshl_add_u32 v72, v74, 8, v75
s_add_u32 s7, s74, 10240
v_add_u32 v72, s7, v72
v_and_b32 v74, 31, v0
v_lshrrev_b32 v75, 5, v0
v_lshlrev_b32 v75, 3, v75
v_and_b32 v73, 15, v0
v_xor_b32 v73, v73, v75
v_lshlrev_b32 v73, 4, v73
v_lshl_add_u32 v73, v74, 8, v73
v_add_u32 v73, s7, v73
ds_write_b128 v72, a[192:195] offset:0
v_xor_b32 v74, 64, v72
ds_write_b128 v74, a[196:199] offset:1024
v_xor_b32 v75, 128, v72
ds_write_b128 v75, a[200:203] offset:2048
v_xor_b32 v74, 192, v72
ds_write_b128 v74, a[204:207] offset:3072
ds_write_b128 v72, a[208:211] offset:4096
v_xor_b32 v74, 64, v72
ds_write_b128 v74, a[212:215] offset:5120
v_xor_b32 v75, 128, v72
ds_write_b128 v75, a[216:219] offset:6144
v_xor_b32 v74, 192, v72
ds_write_b128 v74, a[220:223] offset:7168
s_waitcnt lgkmcnt(0)
ds_read_b128 a[192:195], v73
v_xor_b32 v74, 16, v73
ds_read_b128 a[196:199], v74
v_xor_b32 v75, 32, v73
ds_read_b128 a[200:203], v75
v_xor_b32 v74, 48, v73
ds_read_b128 a[204:207], v74
v_xor_b32 v75, 64, v73
ds_read_b128 a[208:211], v75
v_xor_b32 v74, 80, v73
ds_read_b128 a[212:215], v74
v_xor_b32 v75, 96, v73
ds_read_b128 a[216:219], v75
v_xor_b32 v74, 112, v73
ds_read_b128 a[220:223], v74
s_waitcnt lgkmcnt(0)
v_lshrrev_b32 v74, 4, v0
v_and_b32 v75, 15, v0
v_xor_b32 v75, v75, v74
v_lshlrev_b32 v75, 4, v75
v_lshl_add_u32 v72, v74, 8, v75
s_add_u32 s7, s74, 10240
v_add_u32 v72, s7, v72
v_and_b32 v74, 31, v0
v_lshrrev_b32 v75, 5, v0
v_lshlrev_b32 v75, 3, v75
v_and_b32 v73, 15, v0
v_xor_b32 v73, v73, v75
v_lshlrev_b32 v73, 4, v73
v_lshl_add_u32 v73, v74, 8, v73
v_add_u32 v73, s7, v73
ds_write_b128 v72, a[224:227] offset:0
v_xor_b32 v74, 64, v72
ds_write_b128 v74, a[228:231] offset:1024
v_xor_b32 v75, 128, v72
ds_write_b128 v75, a[232:235] offset:2048
v_xor_b32 v74, 192, v72
ds_write_b128 v74, a[236:239] offset:3072
ds_write_b128 v72, a[240:243] offset:4096
v_xor_b32 v74, 64, v72
ds_write_b128 v74, a[244:247] offset:5120
v_xor_b32 v75, 128, v72
ds_write_b128 v75, a[248:251] offset:6144
v_xor_b32 v74, 192, v72
ds_write_b128 v74, a[252:255] offset:7168
s_waitcnt lgkmcnt(0)
ds_read_b128 a[224:227], v73
v_xor_b32 v74, 16, v73
ds_read_b128 a[228:231], v74
v_xor_b32 v75, 32, v73
ds_read_b128 a[232:235], v75
v_xor_b32 v74, 48, v73
ds_read_b128 a[236:239], v74
v_xor_b32 v75, 64, v73
ds_read_b128 a[240:243], v75
v_xor_b32 v74, 80, v73
ds_read_b128 a[244:247], v74
v_xor_b32 v75, 96, v73
ds_read_b128 a[248:251], v75
v_xor_b32 v74, 112, v73
ds_read_b128 a[252:255], v74
s_waitcnt lgkmcnt(0)
s_waitcnt vmcnt(18)
s_nop 7
s_branch J_A
P_A:
s_nop 7
s_mov_b32 s75, 0
s_sleep 12
PL_50:
s_sleep 8
s_sub_u32 s7, s60, 294912
s_lshl_b32 s76, s58, 11
s_sub_u32 s7, s7, s76
s_add_u32 s7, s7, 32768
buffer_load_dwordx4 v[44:47], v1, s[40:43], s7 offen offset:0 sc1
buffer_load_dwordx4 v[48:51], v1, s[40:43], s7 offen offset:1024 sc1
buffer_load_dwordx4 v[24:27], v1, s[40:43], s61 offen offset:0 sc1
buffer_load_dwordx4 v[28:31], v1, s[40:43], s61 offen offset:1024 sc1
buffer_load_dwordx2 v[32:33], v6, s[40:43], s64 offen sc1
s_waitcnt vmcnt(0)
v_max3_u32 v69, v24, v25, v26
v_max3_u32 v70, v27, v28, v29
v_max3_u32 v69, v69, v30, v31
v_max3_u32 v70, v70, v32, v33
v_max3_u32 v69, v69, v44, v45
v_max3_u32 v70, v70, v46, v47
v_max3_u32 v69, v69, v48, v49
v_max3_u32 v70, v70, v50, v51
v_max_u32 v69, v69, v70
v_cmp_eq_u32 vcc, -1, v69
s_and_b64 vcc, vcc, exec
s_cbranch_scc0 PD_51
s_add_u32 s75, s75, 1
s_cmp_lt_u32 s75, 20000
s_cbranch_scc1 PL_50
PD_51:
s_mov_b32 s75, 0
CSL_52:
v_max3_u32 v52, v44, v45, v46
v_max3_u32 v53, v47, v48, v49
v_max3_u32 v52, v52, v50, v51
v_max_u32 v52, v52, v53
v_cmp_eq_u32 vcc, -1, v52
s_and_b64 vcc, vcc, exec
s_cbranch_scc0 CSD_53
s_sub_u32 s7, s60, 294912
s_lshl_b32 s76, s58, 11
s_sub_u32 s7, s7, s76
s_add_u32 s7, s7, 32768
buffer_load_dwordx4 v[44:47], v1, s[40:43], s7 offen offset:0 sc1
buffer_load_dwordx4 v[48:51], v1, s[40:43], s7 offen offset:1024 sc1
s_waitcnt vmcnt(0)
s_add_u32 s75, s75, 1
s_cmp_lt_u32 s75, 20000
s_cbranch_scc1 CSL_52
CSD_53:
v_add_f32_dpp v44, v44, v44 quad_perm:[1,0,3,2] row_mask:0xf bank_mask:0xf
v_add_f32_dpp v45, v45, v45 quad_perm:[1,0,3,2] row_mask:0xf bank_mask:0xf
v_add_f32_dpp v46, v46, v46 quad_perm:[1,0,3,2] row_mask:0xf bank_mask:0xf
v_add_f32_dpp v47, v47, v47 quad_perm:[1,0,3,2] row_mask:0xf bank_mask:0xf
v_add_f32_dpp v48, v48, v48 quad_perm:[1,0,3,2] row_mask:0xf bank_mask:0xf
v_add_f32_dpp v49, v49, v49 quad_perm:[1,0,3,2] row_mask:0xf bank_mask:0xf
v_add_f32_dpp v50, v50, v50 quad_perm:[1,0,3,2] row_mask:0xf bank_mask:0xf
v_add_f32_dpp v51, v51, v51 quad_perm:[1,0,3,2] row_mask:0xf bank_mask:0xf
v_add_f32_dpp v44, v44, v44 quad_perm:[2,3,0,1] row_mask:0xf bank_mask:0xf
v_add_f32_dpp v45, v45, v45 quad_perm:[2,3,0,1] row_mask:0xf bank_mask:0xf
v_add_f32_dpp v46, v46, v46 quad_perm:[2,3,0,1] row_mask:0xf bank_mask:0xf
v_add_f32_dpp v47, v47, v47 quad_perm:[2,3,0,1] row_mask:0xf bank_mask:0xf
v_add_f32_dpp v48, v48, v48 quad_perm:[2,3,0,1] row_mask:0xf bank_mask:0xf
v_add_f32_dpp v49, v49, v49 quad_perm:[2,3,0,1] row_mask:0xf bank_mask:0xf
v_add_f32_dpp v50, v50, v50 quad_perm:[2,3,0,1] row_mask:0xf bank_mask:0xf
v_add_f32_dpp v51, v51, v51 quad_perm:[2,3,0,1] row_mask:0xf bank_mask:0xf
s_waitcnt lgkmcnt(0)
s_mov_b64 exec, s[70:71]
ds_write_b128 v21, v[44:47]
ds_write_b128 v21, v[48:51] offset:16
s_mov_b64 exec, -1
v_mov_b32 v34, v44
v_mov_b32 v35, v45
v_mov_b32 v36, v46
v_mov_b32 v37, v47
v_mov_b32 v38, v48
v_mov_b32 v39, v49
v_mov_b32 v40, v50
v_mov_b32 v41, v51
s_waitcnt lgkmcnt(0)
s_nop 7
s_branch C_A
S_Q1:
s_nop 7
v_lshrrev_b32 v68, 2, v0
v_lshlrev_b32 v68, 4, v68
v_add_u32 v68, 162944, v68
s_mov_b64 exec, s[70:71]
ds_write_b128 v68, v[76:79]
s_mov_b64 exec, -1
s_waitcnt lgkmcnt(0)
v_mov_b32 v72, 161828
v_mov_b32 v73, 3
s_mov_b64 exec, 1
ds_write_b32 v72, v73
s_mov_b64 exec, -1
s_add_u32 s7, s74, 20480
v_add_u32 v72, s7, v16
ds_write_b128 v72, v[168:171] offset:0
ds_write_b128 v72, v[172:175] offset:1024
ds_write_b128 v72, v[176:179] offset:2048
s_waitcnt lgkmcnt(0)
ds_read_b64_tr_b16 v[168:169], v3 offset:20480
ds_read_b64_tr_b16 v[170:171], v4 offset:20480
ds_read_b64_tr_b16 v[172:173], v3 offset:21504
ds_read_b64_tr_b16 v[174:175], v4 offset:21504
ds_read_b64_tr_b16 v[176:177], v3 offset:22528
ds_read_b64_tr_b16 v[178:179], v4 offset:22528
s_waitcnt lgkmcnt(0)
s_add_u32 s7, s74, 20480
v_add_u32 v72, s7, v16
ds_write_b128 v72, v[180:183] offset:0
ds_write_b128 v72, v[184:187] offset:1024
ds_write_b128 v72, v[188:191] offset:2048
s_waitcnt lgkmcnt(0)
ds_read_b64_tr_b16 v[180:181], v3 offset:20480
ds_read_b64_tr_b16 v[182:183], v4 offset:20480
ds_read_b64_tr_b16 v[184:185], v3 offset:21504
ds_read_b64_tr_b16 v[186:187], v4 offset:21504
ds_read_b64_tr_b16 v[188:189], v3 offset:22528
ds_read_b64_tr_b16 v[190:191], v4 offset:22528
s_waitcnt lgkmcnt(0)
s_add_u32 s7, s74, 20480
v_add_u32 v72, s7, v16
ds_write_b128 v72, v[192:195] offset:0
ds_write_b128 v72, v[196:199] offset:1024
ds_write_b128 v72, v[200:203] offset:2048
s_waitcnt lgkmcnt(0)
ds_read_b64_tr_b16 v[192:193], v3 offset:20480
ds_read_b64_tr_b16 v[194:195], v4 offset:20480
ds_read_b64_tr_b16 v[196:197], v3 offset:21504
ds_read_b64_tr_b16 v[198:199], v4 offset:21504
ds_read_b64_tr_b16 v[200:201], v3 offset:22528
ds_read_b64_tr_b16 v[202:203], v4 offset:22528
s_waitcnt lgkmcnt(0)
s_add_u32 s7, s74, 20480
v_add_u32 v72, s7, v16
ds_write_b128 v72, v[204:207] offset:0
ds_write_b128 v72, v[208:211] offset:1024
ds_write_b128 v72, v[212:215] offset:2048
s_waitcnt lgkmcnt(0)
ds_read_b64_tr_b16 v[204:205], v3 offset:20480
ds_read_b64_tr_b16 v[206:207], v4 offset:20480
ds_read_b64_tr_b16 v[208:209], v3 offset:21504
ds_read_b64_tr_b16 v[210:211], v4 offset:21504
ds_read_b64_tr_b16 v[212:213], v3 offset:22528
ds_read_b64_tr_b16 v[214:215], v4 offset:22528
s_waitcnt lgkmcnt(0)
s_mov_b32 s7, 73728
buffer_load_dwordx4 v[240:243], v1, s[20:23], s7 offen nt
s_mov_b32 s7, 77824
buffer_load_dwordx4 v[244:247], v1, s[20:23], s7 offen nt
s_mov_b32 s7, 81920
buffer_load_dwordx4 v[248:251], v1, s[20:23], s7 offen nt
s_mov_b32 s7, 86016
buffer_load_dwordx4 v[252:255], v1, s[20:23], s7 offen nt
s_mov_b32 s7, 90112
s_add_u32 m0, s74, 10240
s_nop 0
buffer_load_dwordx4 v16, s[20:23], s7 offen nt lds
s_mov_b32 s7, 94208
s_add_u32 m0, s74, 11264
s_nop 0
buffer_load_dwordx4 v16, s[20:23], s7 offen nt lds
s_mov_b32 s7, 98304
s_add_u32 m0, s74, 12288
s_nop 0
buffer_load_dwordx4 v16, s[20:23], s7 offen nt lds
s_mov_b32 s7, 102400
s_add_u32 m0, s74, 13312
s_nop 0
buffer_load_dwordx4 v16, s[20:23], s7 offen nt lds
s_mov_b32 s7, 106496
s_add_u32 m0, s74, 14336
s_nop 0
buffer_load_dwordx4 v16, s[20:23], s7 offen nt lds
s_mov_b32 s7, 110592
s_add_u32 m0, s74, 15360
s_nop 0
buffer_load_dwordx4 v16, s[20:23], s7 offen nt lds
s_mov_b32 s7, 114688
s_add_u32 m0, s74, 16384
s_nop 0
buffer_load_dwordx4 v16, s[20:23], s7 offen nt lds
s_mov_b32 s7, 118784
s_add_u32 m0, s74, 17408
s_nop 0
buffer_load_dwordx4 v16, s[20:23], s7 offen nt lds
s_mov_b32 s7, 122880
s_add_u32 m0, s74, 18432
s_nop 0
buffer_load_dwordx4 v16, s[20:23], s7 offen nt lds
s_mov_b32 s7, 126976
s_add_u32 m0, s74, 19456
s_nop 0
buffer_load_dwordx4 v16, s[20:23], s7 offen nt lds
s_waitcnt vmcnt(18)
s_nop 7
s_branch J_F
S_PV_1:
s_nop 7
s_waitcnt lgkmcnt(0)
s_add_u32 s7, s74, 20480
v_add_u32 v72, s7, v16
ds_write_b128 v72, v[216:219] offset:0
ds_write_b128 v72, v[220:223] offset:1024
ds_write_b128 v72, v[224:227] offset:2048
s_waitcnt lgkmcnt(0)
ds_read_b64_tr_b16 v[216:217], v3 offset:20480
ds_read_b64_tr_b16 v[218:219], v4 offset:20480
ds_read_b64_tr_b16 v[220:221], v3 offset:21504
ds_read_b64_tr_b16 v[222:223], v4 offset:21504
ds_read_b64_tr_b16 v[224:225], v3 offset:22528
ds_read_b64_tr_b16 v[226:227], v4 offset:22528
s_waitcnt lgkmcnt(0)
s_waitcnt vmcnt(14)
s_add_u32 s7, s74, 20480
v_add_u32 v72, s7, v16
ds_write_b128 v72, v[228:231] offset:0
ds_write_b128 v72, v[232:235] offset:1024
ds_write_b128 v72, v[236:239] offset:2048
s_waitcnt lgkmcnt(0)
ds_read_b64_tr_b16 v[228:229], v3 offset:20480
ds_read_b64_tr_b16 v[230:231], v4 offset:20480
ds_read_b64_tr_b16 v[232:233], v3 offset:21504
ds_read_b64_tr_b16 v[234:235], v4 offset:21504
ds_read_b64_tr_b16 v[236:237], v3 offset:22528
ds_read_b64_tr_b16 v[238:239], v4 offset:22528
s_waitcnt lgkmcnt(0)
s_waitcnt vmcnt(10)
s_add_u32 s7, s74, 20480
v_add_u32 v72, s7, v16
ds_write_b128 v72, v[240:243] offset:0
ds_write_b128 v72, v[244:247] offset:1024
ds_write_b128 v72, v[248:251] offset:2048
s_waitcnt lgkmcnt(0)
ds_read_b64_tr_b16 v[240:241], v3 offset:20480
ds_read_b64_tr_b16 v[242:243], v4 offset:20480
ds_read_b64_tr_b16 v[244:245], v3 offset:21504
ds_read_b64_tr_b16 v[246:247], v4 offset:21504
ds_read_b64_tr_b16 v[248:249], v3 offset:22528
ds_read_b64_tr_b16 v[250:251], v4 offset:22528
s_waitcnt lgkmcnt(0)
s_add_u32 s7, s74, 20480
v_add_u32 v72, s7, v16
ds_write_b128 v72, v[252:255] offset:0
s_waitcnt lgkmcnt(0)
ds_read_b64_tr_b16 v[252:253], v3 offset:20480
ds_read_b64_tr_b16 v[254:255], v4 offset:20480
s_waitcnt lgkmcnt(0)
s_waitcnt vmcnt(6)
s_waitcnt vmcnt(2)
s_waitcnt vmcnt(0)
ds_read_b64_tr_b16 v[44:45], v3 offset:10240
ds_read_b64_tr_b16 v[46:47], v4 offset:10240
ds_read_b64_tr_b16 v[48:49], v3 offset:11264
ds_read_b64_tr_b16 v[50:51], v4 offset:11264
ds_read_b64_tr_b16 v[52:53], v3 offset:12288
ds_read_b64_tr_b16 v[54:55], v4 offset:12288
ds_read_b64_tr_b16 v[56:57], v3 offset:13312
ds_read_b64_tr_b16 v[58:59], v4 offset:13312
ds_read_b64_tr_b16 v[60:61], v3 offset:14336
ds_read_b64_tr_b16 v[62:63], v4 offset:14336
s_nop 7
s_branch R_PV
.section .rodata,"a"
.p2align 6
.amdhsa_kernel interleave_layers__sliding_block_cached__sliding_block_cached__decode_kernel
  .amdhsa_next_free_vgpr 512
  .amdhsa_next_free_sgpr 102
  .amdhsa_accum_offset 256
  .amdhsa_group_segment_fixed_size 0
  .amdhsa_kernarg_size 104
  .amdhsa_user_sgpr_count 2
  .amdhsa_user_sgpr_kernarg_segment_ptr 1
  .amdhsa_system_sgpr_workgroup_id_x 1
  .amdhsa_float_denorm_mode_32 3
.end_amdhsa_kernel
```
